```python
import torch

def _softmax(x, axis=-1):
    return torch.softmax(x, dim=axis)

def _gelu(x):
    return torch.nn.functional.gelu(x, approximate='tanh')

def _silu(x):
    return torch.nn.functional.silu(x)

def _sigmoid(x):
    return torch.sigmoid(x)

def _layernorm(x, axis=-1, eps=1e-05):
    m = x.mean(dim=axis, keepdim=True)
    v = x.var(dim=axis, keepdim=True, unbiased=False)
    return (x - m) / torch.sqrt(v + eps)

def _scatter_add(tgt, idx, src, axis=0):
    return tgt.clone().index_add_(axis, idx, src)

def _segment_sum(src, seg, n):
    out = torch.zeros((n,) + src.shape[1:], dtype=src.dtype)
    return out.index_add_(0, seg, src)

def _pad(x, pw):
    flat = tuple((v for pair in reversed(pw) for v in pair))
    return torch.nn.functional.pad(x, flat)
kernel_name = 'standalone__window_attn_twins__vision'

def setup_inputs():

    _w = lambda a: (lambda t: t.to(torch.bfloat16) if t.is_floating_point() else t)(torch.as_tensor(a))
    H = W = 224 // 7 * 7
    C = 96
    return {'x': _w((lambda *s: torch.randn(*s, dtype=torch.bfloat16) * 0.8)(1, H, W, C)), 'wq': _w((lambda *s: torch.randn(*s, dtype=torch.bfloat16) * 0.8)(C, C)), 'wkv': _w((lambda *s: torch.randn(*s, dtype=torch.bfloat16) * 0.8)(C, 2 * C)), 'wo': _w((lambda *s: torch.randn(*s, dtype=torch.bfloat16) * 0.05)(C, C))}

def reference(x, wq, wkv, wo):
    B, H, W, C = x.shape
    win = 7
    nh, nw = (H // win, W // win)
    xs = x.reshape(B, nh, win, nw, win, C).mean(axis=(2, 4)).reshape(B, nh * nw, C)
    q = x.reshape(B, H * W, C) @ wq
    kv = xs @ wkv
    k, v = (kv[..., :C].clone(), kv[..., C:].clone())
    scale = C ** (-0.5)
    p = _softmax(torch.einsum('bqc,bkc->bqk', q, k) * scale, axis=-1)
    o = torch.einsum('bqk,bkc->bqc', p, v) @ wo
    return o.reshape(B, H, W, C)
```

```asm
; @launch grid=(256,1,1) block=(256,1,1) lds=163328
.amdgcn_target "amdgcn-amd-amdhsa--gfx950"
.text
.p2align 12
.globl standalone__window_attn_twins__vision_kernel
.p2align 8
.type standalone__window_attn_twins__vision_kernel,@function
standalone__window_attn_twins__vision_kernel:
    s_cmp_ge_u32 s2, 256
    s_cbranch_scc1 L_end
    s_load_dwordx8 s[4:11], s[0:1], 0
    s_load_dwordx4 s[12:15], s[0:1], 32
    s_load_dwordx2 s[16:17], s[0:1], 48
    s_getpc_b64 s[64:65]
L_pc:
    v_lshlrev_b32 v2, 7, v0
    v_min_u32 v2, L_end - L_pc, v2
    v_mov_b32 v3, s65
    v_add_co_u32 v2, vcc, s64, v2
    s_nop 1
    v_addc_co_u32 v3, vcc, 0, v3, vcc
    global_load_dword v4, v[2:3], off
    s_memrealtime s[66:67]
    v_lshrrev_b32 v19, 6, v0
    v_and_b32 v200, 63, v0
    v_readfirstlane_b32 s48, v19
    v_lshlrev_b32 v1, 4, v200
    s_lshr_b32 s50, s2, 3
    s_and_b32 s51, s2, 7
    s_mul_i32 s3, s50, 301056
    s_mul_i32 s51, s51, 5376
    s_add_u32 s3, s3, s51
    s_mul_i32 s49, s48, 12288
    s_and_b32 s19, s48, 1
    s_lshl_b32 s18, s19, 6
    v_add_u32 v216, s18, v200
    v_mul_u32_u24 v217, 2731, v216
    v_lshrrev_b32 v217, 16, v217
    v_mul_u32_u24 v218, 24, v217
    v_sub_u32 v216, v216, v218
    v_and_b32 v218, 6, v217
    v_xor_b32 v216, v216, v218
    v_mul_u32_u24 v217, 384, v217
    v_lshl_add_u32 v206, v216, 4, v217
    v_mov_b32 v19, 37632
    v_cmp_le_u32 vcc, 16, v200
    s_nop 1
    v_cndmask_b32 v203, 0, v19, vcc
    v_add_u32 v203, v203, v1
    v_cmp_le_u32 vcc, 32, v200
    s_nop 1
    v_cndmask_b32 v204, 0, v19, vcc
    v_add_u32 v204, v204, v1
    v_cmp_le_u32 vcc, 48, v200
    s_nop 1
    v_cndmask_b32 v205, 0, v19, vcc
    v_add_u32 v205, v205, v1
    s_waitcnt lgkmcnt(0)
    s_mov_b32 s24, s4
    s_and_b32 s25, s5, 0xffff
    s_mov_b32 s26, 9633792
    s_mov_b32 s27, 0x20000
    s_cmp_ge_u32 s48, 2
    s_cbranch_scc1 L_wpath
    s_mul_i32 s50, s48, 172032
    s_add_u32 s50, s50, s3
    s_mul_i32 s51, s48, 21504
    s_add_u32 s51, s51, 49152
    s_add_u32 m0, s51, 0
    s_add_u32 s58, s50, 0
    buffer_load_dwordx4 v1, s[24:27], s58 offen offset:0 nt lds
    buffer_load_dwordx4 v1, s[24:27], s58 offen offset:1024 nt lds
    buffer_load_dwordx4 v1, s[24:27], s58 offen offset:2048 nt lds
    buffer_load_dwordx4 v1, s[24:27], s58 offen offset:3072 nt lds
    s_add_u32 m0, s51, 4096
    s_add_u32 s58, s50, 4096
    buffer_load_dwordx4 v1, s[24:27], s58 offen offset:0 nt lds
    buffer_load_dwordx4 v203, s[24:27], s58 offen offset:1024 nt lds
    s_add_u32 m0, s51, 6144
    s_add_u32 s58, s50, 43776
    buffer_load_dwordx4 v1, s[24:27], s58 offen offset:0 nt lds
    buffer_load_dwordx4 v1, s[24:27], s58 offen offset:1024 nt lds
    buffer_load_dwordx4 v1, s[24:27], s58 offen offset:2048 nt lds
    buffer_load_dwordx4 v1, s[24:27], s58 offen offset:3072 nt lds
    s_add_u32 m0, s51, 10240
    s_add_u32 s58, s50, 47872
    buffer_load_dwordx4 v204, s[24:27], s58 offen offset:0 nt lds
    s_add_u32 m0, s51, 11264
    s_add_u32 s58, s50, 86528
    buffer_load_dwordx4 v1, s[24:27], s58 offen offset:0 nt lds
    buffer_load_dwordx4 v1, s[24:27], s58 offen offset:1024 nt lds
    buffer_load_dwordx4 v1, s[24:27], s58 offen offset:2048 nt lds
    buffer_load_dwordx4 v1, s[24:27], s58 offen offset:3072 nt lds
    s_add_u32 m0, s51, 15360
    s_add_u32 s58, s50, 90624
    buffer_load_dwordx4 v205, s[24:27], s58 offen offset:0 nt lds
    s_add_u32 m0, s51, 16384
    s_add_u32 s58, s50, 129280
    buffer_load_dwordx4 v1, s[24:27], s58 offen offset:0 nt lds
    s_cmp_eq_u32 s48, 1
    s_cbranch_scc1 L_xdone
    s_add_u32 m0, s51, 17408
    s_add_u32 s58, s50, 130304
    buffer_load_dwordx4 v1, s[24:27], s58 offen offset:0 nt lds
    buffer_load_dwordx4 v1, s[24:27], s58 offen offset:1024 nt lds
    buffer_load_dwordx4 v1, s[24:27], s58 offen offset:2048 nt lds
    buffer_load_dwordx4 v1, s[24:27], s58 offen offset:3072 nt lds
    s_mov_b32 s44, s14
    s_and_b32 s45, s15, 0xffff
    s_mov_b32 s46, 256
    s_mov_b32 s47, 0x20000
    s_cmp_lg_u32 s2, 0
    s_cbranch_scc1 L_nononce
    s_or_b32 s66, s66, 1
    v_mov_b32 v18, s66
    v_lshlrev_b32 v19, 8, v200
    buffer_store_dword v18, v19, s[44:47], 0 offen sc1
L_nononce:
L_xdone:
    s_mov_b32 s44, s14
    s_and_b32 s45, s15, 0xffff
    s_mov_b32 s46, 256
    s_mov_b32 s47, 0x20000
    s_mov_b32 s20, s16
    s_and_b32 s21, s17, 0xffff
    s_mov_b32 s22, 4587520
    s_mov_b32 s23, 0x20000
    s_mov_b32 s28, s12
    s_and_b32 s29, s13, 0xffff
    s_mov_b32 s30, 9633792
    s_mov_b32 s31, 0x20000
    v_add_u32 v216, 128, v200
    v_mul_u32_u24 v217, 2731, v216
    v_lshrrev_b32 v217, 16, v217
    v_mul_u32_u24 v218, 24, v217
    v_sub_u32 v216, v216, v218
    v_and_b32 v218, 6, v217
    v_xor_b32 v216, v216, v218
    v_mul_u32_u24 v217, 384, v217
    v_lshl_add_u32 v207, v216, 4, v217
    v_and_b32 v201, 15, v200
    v_lshrrev_b32 v202, 4, v200
    v_lshrrev_b32 v216, 2, v201
    v_and_b32 v217, 3, v201
    v_mul_u32_u24 v16, 192, v217
    v_lshl_add_u32 v16, v202, 4, v16
    s_mov_b32 s18, 301056
    v_mad_u32_u24 v16, v216, s18, v16
    s_add_u32 s18, s3, 262656
    s_bfe_u32 s59, s2, 0x20003
    s_cmp_eq_u32 s59, 0
    s_cselect_b32 s18, s18, 0x80000000
    v_add_u32 v16, s18, v16
    v_lshl_add_u32 v218, v202, 3, v216
    v_mul_u32_u24 v212, 192, v218
    v_lshl_add_u32 v212, v217, 3, v212
    v_and_b32 v219, 1, v202
    v_lshlrev_b32 v219, 5, v219
    v_add_u32 v223, 143360, v212
    v_add_u32 v222, v223, v219
    v_sub_u32 v223, v223, v219
    s_lshl_b32 s18, s48, 6
    s_add_u32 s59, s18, 49152
    v_add_u32 v212, s59, v212
    v_lshl_add_u32 v218, v202, 2, v216
    v_mul_u32_u24 v215, 192, v218
    v_lshl_add_u32 v215, v217, 4, v215
    s_add_u32 s59, s18, 124864
    v_add_u32 v215, s59, v215
    v_mul_u32_u24 v221, 384, v218
    v_lshl_add_u32 v221, v217, 3, v221
    v_add_u32 v221, 88064, v221
    v_bfe_u32 v219, v218, 1, 2
    s_cmp_eq_u32 s48, 0
    s_cselect_b32 s18, 0, 6
    v_xor_b32 v216, s18, v219
    v_lshl_add_u32 v244, v216, 5, v221
    s_add_u32 s18, s18, 1
    v_xor_b32 v216, s18, v219
    v_lshl_add_u32 v245, v216, 5, v221
    s_add_u32 s18, s18, 1
    v_xor_b32 v216, s18, v219
    v_lshl_add_u32 v246, v216, 5, v221
    s_add_u32 s18, s18, 1
    v_xor_b32 v216, s18, v219
    v_lshl_add_u32 v247, v216, 5, v221
    s_add_u32 s18, s18, 1
    v_xor_b32 v216, s18, v219
    v_lshl_add_u32 v248, v216, 5, v221
    s_add_u32 s18, s18, 1
    v_xor_b32 v216, s18, v219
    v_lshl_add_u32 v249, v216, 5, v221
    s_add_u32 s18, s18, 1
    v_mul_u32_u24 v216, 7, v201
    v_lshlrev_b32 v217, 3, v202
    v_sub_u32 v216, v217, v216
    v_cmp_gt_u32 vcc, 4, v201
    v_mov_b32 v217, 100
    v_mov_b32 v218, 0x3f80
    v_cndmask_b32 v216, v217, v216, vcc
    v_mov_b32 v219, 0x3f800000
    v_add_u32 v217, 0, v216
    v_cmp_gt_u32 vcc, 7, v217
    s_nop 1
    v_cndmask_b32 v208, 0, v218, vcc
    v_add_u32 v217, 1, v216
    v_cmp_gt_u32 vcc, 7, v217
    s_nop 1
    v_cndmask_b32 v217, 0, v219, vcc
    v_or_b32 v208, v208, v217
    v_add_u32 v217, 2, v216
    v_cmp_gt_u32 vcc, 7, v217
    s_nop 1
    v_cndmask_b32 v209, 0, v218, vcc
    v_add_u32 v217, 3, v216
    v_cmp_gt_u32 vcc, 7, v217
    s_nop 1
    v_cndmask_b32 v217, 0, v219, vcc
    v_or_b32 v209, v209, v217
    v_add_u32 v217, 4, v216
    v_cmp_gt_u32 vcc, 7, v217
    s_nop 1
    v_cndmask_b32 v210, 0, v218, vcc
    v_add_u32 v217, 5, v216
    v_cmp_gt_u32 vcc, 7, v217
    s_nop 1
    v_cndmask_b32 v217, 0, v219, vcc
    v_or_b32 v210, v210, v217
    v_add_u32 v217, 6, v216
    v_cmp_gt_u32 vcc, 7, v217
    s_nop 1
    v_cndmask_b32 v211, 0, v218, vcc
    v_add_u32 v217, 7, v216
    v_cmp_gt_u32 vcc, 7, v217
    s_nop 1
    v_cndmask_b32 v217, 0, v219, vcc
    v_or_b32 v211, v211, v217
    v_lshl_add_u32 v221, v202, 2, v201
    v_lshlrev_b32 v221, 4, v221
    v_add_u32 v221, 161792, v221
    s_lshl_b32 s59, s48, 8
    v_add_u32 v220, s59, v221
    s_mov_b32 s96, 0x000f000f
    s_mov_b32 s97, 0x000f000f
    s_and_b32 s59, s2, 7
    s_mul_i32 s59, s59, 49152
    s_lshr_b32 s52, s2, 6
    s_mul_i32 s52, s52, 12288
    s_add_u32 s59, s59, s52
    s_bfe_u32 s52, s2, 0x20003
    s_bfe_u32 s53, s2, 0x10005
    s_mul_i32 s54, s53, 3072
    s_add_u32 s54, s54, s59
    s_lshl_b32 s18, s52, 6
    s_add_u32 s54, s54, s18
    v_add_u32 v213, s54, v1
    v_mov_b32 v218, 0x80000000
    s_lshl_b32 s54, s52, 8
    s_add_u32 s54, s54, s59
    s_lshl_b32 s18, s53, 3
    s_add_u32 s54, s54, s18
    s_lshl_b32 s18, s48, 11
    s_add_u32 s54, s54, s18
    s_add_u32 s54, s54, 4096
    v_lshlrev_b32 v214, 4, v200
    v_add_u32 v214, s54, v214
    v_cmp_gt_u32 vcc, 16, v200
    s_and_b32 s59, s2, 7
    s_mul_i32 s59, s59, 4096
    s_mul_i32 s52, s48, 1024
    s_add_u32 s59, s59, s52
    s_add_u32 s59, s59, 393216
    v_cndmask_b32 v214, v218, v214, vcc
    v_lshrrev_b32 v216, 3, v200
    v_and_b32 v217, 7, v200
    v_mul_u32_u24 v216, 128, v216
    v_lshl_add_u32 v17, v217, 2, v216
    v_add_u32 v17, s59, v17
    v_mov_b32 v232, 0
    v_mov_b32 v233, 0
    v_mov_b32 v234, 0
    v_mov_b32 v235, 0
    v_mov_b32 v236, 0
    v_mov_b32 v237, 0
    v_mov_b32 v238, 0
    v_mov_b32 v239, 0
    v_mov_b32 v240, 0
    v_mov_b32 v241, 0
    v_mov_b32 v242, 0
    v_mov_b32 v243, 0
    v_and_b32 v216, 3, v200
    v_lshl_add_u32 v203, v202, 2, v216
    v_lshlrev_b32 v203, 4, v203
    v_add_u32 v203, 162560, v203
    v_mov_b32 v217, 0x3f803f80
    v_cmp_eq_u32 vcc, 0, v216
    v_mov_b32 v219, 0x44444444
    v_mov_b32 v218, 0xeeeeeeee
    v_cndmask_b32 v255, 0, v217, vcc
    v_cmp_gt_u32 vcc, 2, v216
    v_accvgpr_write_b32 a240, v255
    v_accvgpr_write_b32 a241, v255
    v_accvgpr_write_b32 a242, v255
    v_accvgpr_write_b32 a243, v255
    v_cndmask_b32 v217, 0, v217, vcc
    v_cmp_eq_u32 vcc, 1, v216
    v_accvgpr_write_b32 a244, v217
    v_accvgpr_write_b32 a245, v217
    v_accvgpr_write_b32 a246, v217
    v_accvgpr_write_b32 a247, v217
    v_cndmask_b32 v255, v219, v218, vcc
    v_accvgpr_write_b32 a248, 0
    v_accvgpr_write_b32 a249, 0
    v_accvgpr_write_b32 a250, 0
    v_accvgpr_write_b32 a251, 0
    s_add_u32 s59, s48, 0
    s_and_b32 s59, s59, 3
    s_mul_i32 s59, s59, 12288
    v_add_u32 v6, s59, v1
    s_add_u32 s59, s48, 1
    s_and_b32 s59, s59, 3
    s_mul_i32 s59, s59, 12288
    v_add_u32 v7, s59, v1
    s_add_u32 s59, s48, 2
    s_and_b32 s59, s59, 3
    s_mul_i32 s59, s59, 12288
    v_add_u32 v8, s59, v1
    s_add_u32 s59, s48, 3
    s_and_b32 s59, s59, 3
    s_mul_i32 s59, s59, 12288
    v_add_u32 v9, s59, v1
    s_mul_i32 s59, s48, 48
    s_mov_b32 s52, 37632
    v_lshlrev_b32 v219, 4, v202
    v_add_u32 v219, s3, v219
    v_add_u32 v216, s59, v201
    s_add_u32 s59, s59, 16
    v_mul_u32_u24 v217, 2341, v216
    v_lshrrev_b32 v217, 16, v217
    v_mul_u32_u24 v216, 192, v216
    v_mad_u32_u24 v216, v217, s52, v216
    v_add_u32 v13, v216, v219
    v_add_u32 v216, s59, v201
    s_add_u32 s59, s59, 16
    v_mul_u32_u24 v217, 2341, v216
    v_lshrrev_b32 v217, 16, v217
    v_mul_u32_u24 v216, 192, v216
    v_mad_u32_u24 v216, v217, s52, v216
    v_add_u32 v14, v216, v219
    v_add_u32 v216, s59, v201
    s_add_u32 s59, s59, 16
    v_mul_u32_u24 v217, 2341, v216
    v_lshrrev_b32 v217, 16, v217
    v_mul_u32_u24 v216, 192, v216
    v_mad_u32_u24 v216, v217, s52, v216
    v_add_u32 v15, v216, v219
    v_add_u32 v10, 0, v1
    v_add_u32 v11, 4096, v1
    v_add_u32 v12, 8192, v1
    s_lshr_b32 s59, s2, 6
    s_mul_i32 s59, s59, 1024
    s_and_b32 s52, s2, 7
    s_mul_i32 s52, s52, 128
    s_add_u32 s59, s59, s52
    s_bfe_u32 s52, s2, 0x30003
    s_lshl_b32 s52, s52, 2
    s_add_u32 s59, s59, s52
    s_add_u32 s59, s59, 393216
    v_mul_u32_u24 v253, 4096, v0
    v_add_u32 v253, s59, v253
    v_cmp_gt_u32 vcc, 8, v0
    v_mov_b32 v218, 0x80000000
    s_mov_b64 s[60:61], -1
    v_cndmask_b32 v253, v218, v253, vcc
    s_mov_b32 s68, 0
    s_mov_b32 s62, 0x01010101
    s_mov_b32 s63, 0x01010101
    v_mul_u32_u24 v254, 192, v201
    v_lshl_add_u32 v254, v202, 4, v254
    s_mul_i32 s59, s48, 9216
    s_add_u32 s59, s59, 49152
    v_add_u32 v254, s59, v254
    v_mfma_f32_32x32x16_bf16 v[88:103], a[248:251], a[248:251], 0
    v_mfma_f32_32x32x16_bf16 v[104:119], a[248:251], a[248:251], 0
    v_mfma_f32_32x32x16_bf16 v[120:135], a[248:251], a[248:251], 0
    v_mfma_f32_32x32x16_bf16 v[136:151], a[248:251], a[248:251], 0
    v_mfma_f32_32x32x16_bf16 v[152:167], a[248:251], a[248:251], 0
    v_mfma_f32_32x32x16_bf16 v[168:183], a[248:251], a[248:251], 0
    v_mfma_f32_32x32x16_bf16 v[184:199], a[248:251], a[248:251], 0
    v_mfma_f32_32x32x16_bf16 a[192:207], a[248:251], a[248:251], 0
    v_mfma_f32_32x32x16_bf16 a[208:223], a[248:251], a[248:251], 0
    v_mfma_f32_32x32x16_bf16 a[224:239], a[248:251], a[248:251], 0
    s_mov_b32 s52, 49152
    s_mov_b32 s53, 98304
    s_mov_b32 s54, 0
    s_mov_b32 s55, 7
    s_call_b64 s[64:65], L_touch2
    s_call_b64 s[66:67], L_touch13
    s_call_b64 s[66:67], L_touch12
    s_waitcnt vmcnt(0)
    s_branch L_barA
L_wpath:
    s_mov_b32 s36, s8
    s_and_b32 s37, s9, 0xffff
    s_mov_b32 s38, 36864
    s_mov_b32 s39, 0x20000
    s_lshl_b32 s51, s19, 10
    s_add_u32 s51, s51, 88064
    s_add_u32 m0, s51, 0
    s_mov_b32 s58, 0
    buffer_load_dwordx4 v206, s[36:39], s58 offen offset:0 lds
    v_add_u32 v216, 128, v200
    v_mul_u32_u24 v217, 2731, v216
    v_lshrrev_b32 v217, 16, v217
    v_mul_u32_u24 v218, 24, v217
    v_sub_u32 v216, v216, v218
    v_and_b32 v218, 6, v217
    v_xor_b32 v216, v216, v218
    v_mul_u32_u24 v217, 384, v217
    v_lshl_add_u32 v207, v216, 4, v217
    v_and_b32 v201, 15, v200
    v_lshrrev_b32 v202, 4, v200
    v_lshrrev_b32 v216, 2, v201
    buffer_load_dwordx4 v206, s[36:39], s58 offen offset:3072 lds
    v_and_b32 v217, 3, v201
    v_mul_u32_u24 v16, 192, v217
    v_lshl_add_u32 v16, v202, 4, v16
    s_mov_b32 s18, 301056
    v_mad_u32_u24 v16, v216, s18, v16
    s_add_u32 s18, s3, 262656
    s_bfe_u32 s59, s2, 0x20003
    s_cmp_eq_u32 s59, 0
    s_cselect_b32 s18, s18, 0x80000000
    v_add_u32 v16, s18, v16
    v_lshl_add_u32 v218, v202, 3, v216
    v_mul_u32_u24 v212, 192, v218
    v_lshl_add_u32 v212, v217, 3, v212
    s_add_u32 m0, s51, 6144
    s_mov_b32 s58, 6144
    buffer_load_dwordx4 v206, s[36:39], s58 offen offset:0 lds
    v_and_b32 v219, 1, v202
    v_lshlrev_b32 v219, 5, v219
    v_add_u32 v223, 143360, v212
    v_add_u32 v222, v223, v219
    v_sub_u32 v223, v223, v219
    s_lshl_b32 s18, s48, 6
    s_add_u32 s59, s18, 49152
    v_add_u32 v212, s59, v212
    v_lshl_add_u32 v218, v202, 2, v216
    v_mul_u32_u24 v215, 192, v218
    v_lshl_add_u32 v215, v217, 4, v215
    s_add_u32 s59, s18, 124864
    buffer_load_dwordx4 v206, s[36:39], s58 offen offset:3072 lds
    v_add_u32 v215, s59, v215
    v_mul_u32_u24 v221, 384, v218
    v_lshl_add_u32 v221, v217, 3, v221
    v_add_u32 v221, 88064, v221
    v_bfe_u32 v219, v218, 1, 2
    s_cmp_eq_u32 s48, 0
    s_cselect_b32 s18, 0, 6
    v_xor_b32 v216, s18, v219
    v_lshl_add_u32 v244, v216, 5, v221
    s_add_u32 s18, s18, 1
    v_xor_b32 v216, s18, v219
    v_lshl_add_u32 v245, v216, 5, v221
    s_add_u32 s18, s18, 1
    s_add_u32 m0, s51, 12288
    s_mov_b32 s58, 12288
    buffer_load_dwordx4 v206, s[36:39], s58 offen offset:0 lds
    v_xor_b32 v216, s18, v219
    v_lshl_add_u32 v246, v216, 5, v221
    s_add_u32 s18, s18, 1
    v_xor_b32 v216, s18, v219
    v_lshl_add_u32 v247, v216, 5, v221
    s_add_u32 s18, s18, 1
    v_xor_b32 v216, s18, v219
    v_lshl_add_u32 v248, v216, 5, v221
    s_add_u32 s18, s18, 1
    v_xor_b32 v216, s18, v219
    v_lshl_add_u32 v249, v216, 5, v221
    s_add_u32 s18, s18, 1
    buffer_load_dwordx4 v206, s[36:39], s58 offen offset:3072 lds
    v_mul_u32_u24 v216, 7, v201
    v_lshlrev_b32 v217, 3, v202
    v_sub_u32 v216, v217, v216
    v_cmp_gt_u32 vcc, 4, v201
    v_mov_b32 v217, 100
    v_mov_b32 v218, 0x3f80
    v_cndmask_b32 v216, v217, v216, vcc
    v_mov_b32 v219, 0x3f800000
    v_add_u32 v217, 0, v216
    v_cmp_gt_u32 vcc, 7, v217
    s_nop 1
    v_cndmask_b32 v208, 0, v218, vcc
    s_add_u32 m0, s51, 18432
    s_mov_b32 s58, 18432
    buffer_load_dwordx4 v206, s[36:39], s58 offen offset:0 lds
    v_add_u32 v217, 1, v216
    v_cmp_gt_u32 vcc, 7, v217
    s_nop 1
    v_cndmask_b32 v217, 0, v219, vcc
    v_or_b32 v208, v208, v217
    v_add_u32 v217, 2, v216
    v_cmp_gt_u32 vcc, 7, v217
    s_nop 1
    v_cndmask_b32 v209, 0, v218, vcc
    v_add_u32 v217, 3, v216
    v_cmp_gt_u32 vcc, 7, v217
    s_nop 1
    buffer_load_dwordx4 v206, s[36:39], s58 offen offset:3072 lds
    v_cndmask_b32 v217, 0, v219, vcc
    v_or_b32 v209, v209, v217
    v_add_u32 v217, 4, v216
    v_cmp_gt_u32 vcc, 7, v217
    s_nop 1
    v_cndmask_b32 v210, 0, v218, vcc
    v_add_u32 v217, 5, v216
    v_cmp_gt_u32 vcc, 7, v217
    s_nop 1
    v_cndmask_b32 v217, 0, v219, vcc
    v_or_b32 v210, v210, v217
    v_add_u32 v217, 6, v216
    s_add_u32 m0, s51, 24576
    s_mov_b32 s58, 24576
    buffer_load_dwordx4 v206, s[36:39], s58 offen offset:0 lds
    v_cmp_gt_u32 vcc, 7, v217
    s_nop 1
    v_cndmask_b32 v211, 0, v218, vcc
    v_add_u32 v217, 7, v216
    v_cmp_gt_u32 vcc, 7, v217
    s_nop 1
    v_cndmask_b32 v217, 0, v219, vcc
    v_or_b32 v211, v211, v217
    v_lshl_add_u32 v221, v202, 2, v201
    v_lshlrev_b32 v221, 4, v221
    v_add_u32 v221, 161792, v221
    s_lshl_b32 s59, s48, 8
    buffer_load_dwordx4 v206, s[36:39], s58 offen offset:3072 lds
    v_add_u32 v220, s59, v221
    s_mov_b32 s96, 0x000f000f
    s_mov_b32 s97, 0x000f000f
    s_and_b32 s59, s2, 7
    s_mul_i32 s59, s59, 49152
    s_lshr_b32 s52, s2, 6
    s_mul_i32 s52, s52, 12288
    s_add_u32 s59, s59, s52
    s_bfe_u32 s52, s2, 0x20003
    s_bfe_u32 s53, s2, 0x10005
    s_mul_i32 s54, s53, 3072
    s_add_u32 s54, s54, s59
    s_add_u32 m0, s51, 30720
    s_mov_b32 s58, 30720
    buffer_load_dwordx4 v206, s[36:39], s58 offen offset:0 lds
    s_lshl_b32 s18, s52, 6
    s_add_u32 s54, s54, s18
    v_add_u32 v213, s54, v1
    v_mov_b32 v218, 0x80000000
    s_lshl_b32 s54, s52, 8
    s_add_u32 s54, s54, s59
    s_lshl_b32 s18, s53, 3
    s_add_u32 s54, s54, s18
    s_lshl_b32 s18, s48, 11
    s_add_u32 s54, s54, s18
    s_add_u32 s54, s54, 4096
    v_lshlrev_b32 v214, 4, v200
    buffer_load_dwordx4 v206, s[36:39], s58 offen offset:3072 lds
    v_add_u32 v214, s54, v214
    v_cmp_gt_u32 vcc, 16, v200
    s_and_b32 s59, s2, 7
    s_mul_i32 s59, s59, 4096
    s_mul_i32 s52, s48, 1024
    s_add_u32 s59, s59, s52
    s_add_u32 s59, s59, 393216
    v_cndmask_b32 v214, v218, v214, vcc
    v_lshrrev_b32 v216, 3, v200
    v_and_b32 v217, 7, v200
    v_mul_u32_u24 v216, 128, v216
    v_lshl_add_u32 v17, v217, 2, v216
    s_mul_i32 s50, s19, 18432
    s_add_u32 s51, s50, 90112
    s_add_u32 m0, s51, 0
    s_add_u32 s58, s50, 0
    buffer_load_dwordx4 v207, s[36:39], s58 offen offset:0 lds
    s_mov_b32 s44, s14
    s_and_b32 s45, s15, 0xffff
    s_mov_b32 s46, 256
    s_mov_b32 s47, 0x20000
    s_mov_b32 s20, s16
    s_and_b32 s21, s17, 0xffff
    s_mov_b32 s22, 4587520
    s_mov_b32 s23, 0x20000
    s_mov_b32 s28, s12
    s_and_b32 s29, s13, 0xffff
    s_mov_b32 s30, 9633792
    s_mov_b32 s31, 0x20000
    buffer_load_dwordx4 v207, s[36:39], s58 offen offset:3072 lds
    v_add_u32 v17, s59, v17
    v_mov_b32 v232, 0
    v_mov_b32 v233, 0
    v_mov_b32 v234, 0
    v_mov_b32 v235, 0
    v_mov_b32 v236, 0
    v_mov_b32 v237, 0
    v_mov_b32 v238, 0
    v_mov_b32 v239, 0
    v_mov_b32 v240, 0
    v_mov_b32 v241, 0
    v_mov_b32 v242, 0
    s_add_u32 m0, s51, 6144
    s_add_u32 s58, s50, 6144
    buffer_load_dwordx4 v207, s[36:39], s58 offen offset:0 lds
    v_mov_b32 v243, 0
    v_and_b32 v216, 3, v200
    v_lshl_add_u32 v203, v202, 2, v216
    v_lshlrev_b32 v203, 4, v203
    v_add_u32 v203, 162560, v203
    v_mov_b32 v217, 0x3f803f80
    v_cmp_eq_u32 vcc, 0, v216
    v_mov_b32 v219, 0x44444444
    v_mov_b32 v218, 0xeeeeeeee
    v_cndmask_b32 v255, 0, v217, vcc
    v_cmp_gt_u32 vcc, 2, v216
    v_accvgpr_write_b32 a240, v255
    buffer_load_dwordx4 v207, s[36:39], s58 offen offset:3072 lds
    v_accvgpr_write_b32 a241, v255
    v_accvgpr_write_b32 a242, v255
    v_accvgpr_write_b32 a243, v255
    v_cndmask_b32 v217, 0, v217, vcc
    v_cmp_eq_u32 vcc, 1, v216
    v_accvgpr_write_b32 a244, v217
    v_accvgpr_write_b32 a245, v217
    v_accvgpr_write_b32 a246, v217
    v_accvgpr_write_b32 a247, v217
    v_cndmask_b32 v255, v219, v218, vcc
    v_accvgpr_write_b32 a248, 0
    v_accvgpr_write_b32 a249, 0
    s_add_u32 m0, s51, 12288
    s_add_u32 s58, s50, 12288
    buffer_load_dwordx4 v207, s[36:39], s58 offen offset:0 lds
    v_accvgpr_write_b32 a250, 0
    v_accvgpr_write_b32 a251, 0
    s_add_u32 s59, s48, 0
    s_and_b32 s59, s59, 3
    s_mul_i32 s59, s59, 12288
    v_add_u32 v6, s59, v1
    s_add_u32 s59, s48, 1
    s_and_b32 s59, s59, 3
    s_mul_i32 s59, s59, 12288
    v_add_u32 v7, s59, v1
    s_add_u32 s59, s48, 2
    s_and_b32 s59, s59, 3
    buffer_load_dwordx4 v207, s[36:39], s58 offen offset:3072 lds
    s_mul_i32 s59, s59, 12288
    v_add_u32 v8, s59, v1
    s_add_u32 s59, s48, 3
    s_and_b32 s59, s59, 3
    s_mul_i32 s59, s59, 12288
    v_add_u32 v9, s59, v1
    s_mul_i32 s59, s48, 48
    s_mov_b32 s52, 37632
    v_lshlrev_b32 v219, 4, v202
    v_add_u32 v219, s3, v219
    v_add_u32 v216, s59, v201
    s_add_u32 s59, s59, 16
    v_mul_u32_u24 v217, 2341, v216
    v_lshrrev_b32 v217, 16, v217
    v_mul_u32_u24 v216, 192, v216
    v_mad_u32_u24 v216, v217, s52, v216
    v_add_u32 v13, v216, v219
    v_add_u32 v216, s59, v201
    s_add_u32 s59, s59, 16
    v_mul_u32_u24 v217, 2341, v216
    v_lshrrev_b32 v217, 16, v217
    v_mul_u32_u24 v216, 192, v216
    v_mad_u32_u24 v216, v217, s52, v216
    v_add_u32 v14, v216, v219
    v_add_u32 v216, s59, v201
    s_add_u32 s59, s59, 16
    v_mul_u32_u24 v217, 2341, v216
    v_lshrrev_b32 v217, 16, v217
    v_mul_u32_u24 v216, 192, v216
    v_mad_u32_u24 v216, v217, s52, v216
    v_add_u32 v15, v216, v219
    v_add_u32 v10, 0, v1
    v_add_u32 v11, 4096, v1
    v_add_u32 v12, 8192, v1
    s_lshr_b32 s59, s2, 6
    s_mul_i32 s59, s59, 1024
    s_and_b32 s52, s2, 7
    s_mul_i32 s52, s52, 128
    s_add_u32 s59, s59, s52
    s_bfe_u32 s52, s2, 0x30003
    s_lshl_b32 s52, s52, 2
    s_add_u32 s59, s59, s52
    s_add_u32 s59, s59, 393216
    v_mul_u32_u24 v253, 4096, v0
    v_add_u32 v253, s59, v253
    v_cmp_gt_u32 vcc, 8, v0
    v_mov_b32 v218, 0x80000000
    s_mov_b64 s[60:61], -1
    v_cndmask_b32 v253, v218, v253, vcc
    s_mov_b32 s68, 0
    s_mov_b32 s62, 0x01010101
    s_mov_b32 s63, 0x01010101
    v_mul_u32_u24 v254, 192, v201
    v_lshl_add_u32 v254, v202, 4, v254
    s_mul_i32 s59, s48, 9216
    s_add_u32 s59, s59, 49152
    v_add_u32 v254, s59, v254
    v_mfma_f32_32x32x16_bf16 v[88:103], a[248:251], a[248:251], 0
    v_mfma_f32_32x32x16_bf16 v[104:119], a[248:251], a[248:251], 0
    v_mfma_f32_32x32x16_bf16 v[120:135], a[248:251], a[248:251], 0
    v_mfma_f32_32x32x16_bf16 v[136:151], a[248:251], a[248:251], 0
    v_mfma_f32_32x32x16_bf16 v[152:167], a[248:251], a[248:251], 0
    v_mfma_f32_32x32x16_bf16 v[168:183], a[248:251], a[248:251], 0
    v_mfma_f32_32x32x16_bf16 v[184:199], a[248:251], a[248:251], 0
    v_mfma_f32_32x32x16_bf16 a[192:207], a[248:251], a[248:251], 0
    v_mfma_f32_32x32x16_bf16 a[208:223], a[248:251], a[248:251], 0
    v_mfma_f32_32x32x16_bf16 a[224:239], a[248:251], a[248:251], 0
    s_mov_b32 s52, 49152
    s_mov_b32 s53, 98304
    s_mov_b32 s54, 0
    s_mov_b32 s55, 7
L_barA:
    s_barrier
    s_cmp_eq_u32 s48, 3
    s_cbranch_scc0 L_sum
    s_mov_b32 s40, s10
    s_and_b32 s41, s11, 0xffff
    s_mov_b32 s42, 18432
    s_mov_b32 s43, 0x20000
    s_mov_b32 m0, 124928
    s_mov_b32 s58, 0
    buffer_load_dwordx4 v1, s[40:43], s58 offen offset:0 lds
    s_mov_b32 s32, s6
    s_and_b32 s33, s7, 0xffff
    buffer_load_dwordx4 v1, s[40:43], s58 offen offset:1024 lds
    s_mov_b32 s34, 18432
    s_mov_b32 s35, 0x20000
    buffer_load_dwordx4 v1, s[40:43], s58 offen offset:2048 lds
    v_add_u32 v216, 0, v200
    v_mul_u32_u24 v217, 5462, v216
    buffer_load_dwordx4 v1, s[40:43], s58 offen offset:3072 lds
    v_lshrrev_b32 v217, 16, v217
    v_mul_u32_u24 v218, 12, v217
    s_mov_b32 m0, 129024
    s_mov_b32 s58, 4096
    buffer_load_dwordx4 v1, s[40:43], s58 offen offset:0 lds
    v_sub_u32 v216, v216, v218
    v_lshrrev_b32 v218, 2, v217
    buffer_load_dwordx4 v1, s[40:43], s58 offen offset:1024 lds
    v_and_b32 v218, 2, v218
    v_xor_b32 v216, v216, v218
    buffer_load_dwordx4 v1, s[40:43], s58 offen offset:2048 lds
    v_mul_u32_u24 v217, 192, v217
    v_lshl_add_u32 v250, v216, 4, v217
    buffer_load_dwordx4 v1, s[40:43], s58 offen offset:3072 lds
    v_add_u32 v216, 64, v200
    v_mul_u32_u24 v217, 5462, v216
    s_mov_b32 m0, 133120
    s_mov_b32 s58, 8192
    buffer_load_dwordx4 v1, s[40:43], s58 offen offset:0 lds
    v_lshrrev_b32 v217, 16, v217
    v_mul_u32_u24 v218, 12, v217
    buffer_load_dwordx4 v1, s[40:43], s58 offen offset:1024 lds
    v_sub_u32 v216, v216, v218
    v_lshrrev_b32 v218, 2, v217
    buffer_load_dwordx4 v1, s[40:43], s58 offen offset:2048 lds
    v_and_b32 v218, 2, v218
    v_xor_b32 v216, v216, v218
    buffer_load_dwordx4 v1, s[40:43], s58 offen offset:3072 lds
    v_mul_u32_u24 v217, 192, v217
    v_lshl_add_u32 v251, v216, 4, v217
    s_mov_b32 m0, 137216
    s_mov_b32 s58, 12288
    buffer_load_dwordx4 v1, s[40:43], s58 offen offset:0 lds
    v_add_u32 v216, 128, v200
    v_mul_u32_u24 v217, 5462, v216
    buffer_load_dwordx4 v1, s[40:43], s58 offen offset:1024 lds
    v_lshrrev_b32 v217, 16, v217
    v_mul_u32_u24 v218, 12, v217
    buffer_load_dwordx4 v1, s[40:43], s58 offen offset:2048 lds
    v_sub_u32 v216, v216, v218
    v_lshrrev_b32 v218, 2, v217
    buffer_load_dwordx4 v1, s[40:43], s58 offen offset:3072 lds
    v_and_b32 v218, 2, v218
    v_xor_b32 v216, v216, v218
    s_mov_b32 m0, 141312
    s_mov_b32 s58, 16384
    buffer_load_dwordx4 v1, s[40:43], s58 offen offset:0 lds
    v_mul_u32_u24 v217, 192, v217
    v_lshl_add_u32 v252, v216, 4, v217
    buffer_load_dwordx4 v1, s[40:43], s58 offen offset:1024 lds
    s_mov_b32 m0, 143360
    s_mov_b32 s58, 0
    buffer_load_dwordx4 v250, s[32:35], s58 offen offset:0 lds
    buffer_load_dwordx4 v250, s[32:35], s58 offen offset:3072 lds
    s_mov_b32 m0, 149504
    s_mov_b32 s58, 6144
    buffer_load_dwordx4 v250, s[32:35], s58 offen offset:0 lds
    buffer_load_dwordx4 v250, s[32:35], s58 offen offset:3072 lds
    s_mov_b32 m0, 155648
    s_mov_b32 s58, 12288
    buffer_load_dwordx4 v250, s[32:35], s58 offen offset:0 lds
    buffer_load_dwordx4 v250, s[32:35], s58 offen offset:3072 lds
    s_mov_b32 m0, 144384
    s_mov_b32 s58, 0
    buffer_load_dwordx4 v251, s[32:35], s58 offen offset:0 lds
    buffer_load_dwordx4 v251, s[32:35], s58 offen offset:3072 lds
    s_mov_b32 m0, 150528
    s_mov_b32 s58, 6144
    buffer_load_dwordx4 v251, s[32:35], s58 offen offset:0 lds
    buffer_load_dwordx4 v251, s[32:35], s58 offen offset:3072 lds
    s_mov_b32 m0, 156672
    s_mov_b32 s58, 12288
    buffer_load_dwordx4 v251, s[32:35], s58 offen offset:0 lds
    buffer_load_dwordx4 v251, s[32:35], s58 offen offset:3072 lds
    s_mov_b32 m0, 145408
    s_mov_b32 s58, 0
    buffer_load_dwordx4 v252, s[32:35], s58 offen offset:0 lds
    buffer_load_dwordx4 v252, s[32:35], s58 offen offset:3072 lds
    s_mov_b32 m0, 151552
    s_mov_b32 s58, 6144
    buffer_load_dwordx4 v252, s[32:35], s58 offen offset:0 lds
    buffer_load_dwordx4 v252, s[32:35], s58 offen offset:3072 lds
    s_mov_b32 m0, 157696
    s_mov_b32 s58, 12288
    buffer_load_dwordx4 v252, s[32:35], s58 offen offset:0 lds
    buffer_load_dwordx4 v252, s[32:35], s58 offen offset:3072 lds
    s_waitcnt vmcnt(36)
    s_branch L_barB
L_sum:
    ds_read_b64_tr_b16 a[48:49], v212 offset:0
    ds_read_b64_tr_b16 a[50:51], v212 offset:768
    ds_read_b64_tr_b16 a[52:53], v212 offset:32
    ds_read_b64_tr_b16 a[54:55], v212 offset:800
    ds_read_b64_tr_b16 a[56:57], v212 offset:5376
    ds_read_b64_tr_b16 a[58:59], v212 offset:6144
    ds_read_b64_tr_b16 a[60:61], v212 offset:5408
    ds_read_b64_tr_b16 a[62:63], v212 offset:6176
    ds_read_b64_tr_b16 a[64:65], v212 offset:10752
    ds_read_b64_tr_b16 a[66:67], v212 offset:11520
    ds_read_b64_tr_b16 a[68:69], v212 offset:10784
    ds_read_b64_tr_b16 a[70:71], v212 offset:11552
    ds_read_b64_tr_b16 a[72:73], v212 offset:16128
    ds_read_b64_tr_b16 a[74:75], v212 offset:16896
    ds_read_b64_tr_b16 a[76:77], v212 offset:16160
    ds_read_b64_tr_b16 a[78:79], v212 offset:16928
    s_waitcnt lgkmcnt(12)
    v_mfma_f32_16x16x32_bf16 v[224:227], a[48:51], v[208:211], 0
    v_mfma_f32_16x16x32_bf16 v[228:231], a[52:55], v[208:211], 0
    ds_read_b64_tr_b16 a[80:81], v212 offset:21504
    ds_read_b64_tr_b16 a[82:83], v212 offset:22272
    ds_read_b64_tr_b16 a[84:85], v212 offset:21536
    ds_read_b64_tr_b16 a[86:87], v212 offset:22304
    s_waitcnt lgkmcnt(12)
    v_mfma_f32_16x16x32_bf16 v[224:227], a[56:59], v[208:211], v[224:227]
    v_mfma_f32_16x16x32_bf16 v[228:231], a[60:63], v[208:211], v[228:231]
    ds_read_b64_tr_b16 a[88:89], v212 offset:26880
    ds_read_b64_tr_b16 a[90:91], v212 offset:27648
    ds_read_b64_tr_b16 a[92:93], v212 offset:26912
    ds_read_b64_tr_b16 a[94:95], v212 offset:27680
    s_waitcnt lgkmcnt(12)
    v_mfma_f32_16x16x32_bf16 v[224:227], a[64:67], v[208:211], v[224:227]
    v_mfma_f32_16x16x32_bf16 v[228:231], a[68:71], v[208:211], v[228:231]
    ds_read_b64_tr_b16 a[96:97], v212 offset:32256
    ds_read_b64_tr_b16 a[98:99], v212 offset:33024
    ds_read_b64_tr_b16 a[100:101], v212 offset:32288
    ds_read_b64_tr_b16 a[102:103], v212 offset:33056
    s_waitcnt lgkmcnt(12)
    v_mfma_f32_16x16x32_bf16 v[224:227], a[72:75], v[208:211], v[224:227]
    v_mfma_f32_16x16x32_bf16 v[228:231], a[76:79], v[208:211], v[228:231]
    s_waitcnt lgkmcnt(8)
    v_mfma_f32_16x16x32_bf16 v[224:227], a[80:83], v[208:211], v[224:227]
    v_mfma_f32_16x16x32_bf16 v[228:231], a[84:87], v[208:211], v[228:231]
    s_waitcnt lgkmcnt(4)
    v_mfma_f32_16x16x32_bf16 v[224:227], a[88:91], v[208:211], v[224:227]
    v_mfma_f32_16x16x32_bf16 v[228:231], a[92:95], v[208:211], v[228:231]
    s_waitcnt lgkmcnt(0)
    v_mfma_f32_16x16x32_bf16 v[224:227], a[96:99], v[208:211], v[224:227]
    v_mfma_f32_16x16x32_bf16 v[228:231], a[100:103], v[208:211], v[228:231]
    s_mov_b32 s50, 1017589509
    s_nop 5
    v_mul_f32 v224, s50, v224
    v_mul_f32 v225, s50, v225
    v_mul_f32 v226, s50, v226
    v_mul_f32 v227, s50, v227
    v_mul_f32 v228, s50, v228
    v_mul_f32 v229, s50, v229
    v_mul_f32 v230, s50, v230
    v_mul_f32 v231, s50, v231
    v_cvt_pk_bf16_f32 v224, v224, v225
    v_cvt_pk_bf16_f32 v225, v226, v227
    v_cvt_pk_bf16_f32 v226, v228, v229
    v_cvt_pk_bf16_f32 v227, v230, v231
    s_mov_b64 exec, s[96:97]
    ds_write_b128 v220, v[224:227]
    s_mov_b64 exec, -1
    s_waitcnt vmcnt(0) lgkmcnt(0)
L_barB:
    s_barrier
    s_mov_b64 exec, s[96:97]
    ds_read_b128 v[232:235], v221 offset:0
    ds_read_b128 v[236:239], v221 offset:256
    ds_read_b128 v[240:243], v221 offset:512
    s_mov_b64 exec, -1
    ds_read_b64_tr_b16 a[48:49], v244 offset:0
    ds_read_b64_tr_b16 a[50:51], v244 offset:6144
    ds_read_b64_tr_b16 a[60:61], v245 offset:0
    ds_read_b64_tr_b16 a[62:63], v245 offset:6144
    ds_read_b64_tr_b16 a[72:73], v246 offset:0
    ds_read_b64_tr_b16 a[74:75], v246 offset:6144
    ds_read_b64_tr_b16 a[84:85], v247 offset:0
    ds_read_b64_tr_b16 a[86:87], v247 offset:6144
    ds_read_b64_tr_b16 a[96:97], v248 offset:0
    ds_read_b64_tr_b16 a[98:99], v248 offset:6144
    ds_read_b64_tr_b16 a[108:109], v249 offset:0
    ds_read_b64_tr_b16 a[110:111], v249 offset:6144
    ds_read_b64_tr_b16 a[52:53], v244 offset:12288
    ds_read_b64_tr_b16 a[54:55], v244 offset:18432
    ds_read_b64_tr_b16 a[64:65], v245 offset:12288
    ds_read_b64_tr_b16 a[66:67], v245 offset:18432
    ds_read_b64_tr_b16 a[76:77], v246 offset:12288
    ds_read_b64_tr_b16 a[78:79], v246 offset:18432
    ds_read_b64_tr_b16 a[88:89], v247 offset:12288
    ds_read_b64_tr_b16 a[90:91], v247 offset:18432
    ds_read_b64_tr_b16 a[100:101], v248 offset:12288
    ds_read_b64_tr_b16 a[102:103], v248 offset:18432
    ds_read_b64_tr_b16 a[112:113], v249 offset:12288
    ds_read_b64_tr_b16 a[114:115], v249 offset:18432
    s_waitcnt lgkmcnt(12)
    v_mfma_f32_16x16x32_bf16 v[20:23], a[48:51], v[232:235], 0
    v_mfma_f32_16x16x32_bf16 v[24:27], a[60:63], v[232:235], 0
    v_mfma_f32_16x16x32_bf16 v[28:31], a[72:75], v[232:235], 0
    v_mfma_f32_16x16x32_bf16 v[32:35], a[84:87], v[232:235], 0
    v_mfma_f32_16x16x32_bf16 v[36:39], a[96:99], v[232:235], 0
    v_mfma_f32_16x16x32_bf16 v[40:43], a[108:111], v[232:235], 0
    ds_read_b64_tr_b16 a[56:57], v244 offset:24576
    ds_read_b64_tr_b16 a[58:59], v244 offset:30720
    ds_read_b64_tr_b16 a[68:69], v245 offset:24576
    ds_read_b64_tr_b16 a[70:71], v245 offset:30720
    ds_read_b64_tr_b16 a[80:81], v246 offset:24576
    ds_read_b64_tr_b16 a[82:83], v246 offset:30720
    ds_read_b64_tr_b16 a[92:93], v247 offset:24576
    ds_read_b64_tr_b16 a[94:95], v247 offset:30720
    ds_read_b64_tr_b16 a[104:105], v248 offset:24576
    ds_read_b64_tr_b16 a[106:107], v248 offset:30720
    ds_read_b64_tr_b16 a[116:117], v249 offset:24576
    ds_read_b64_tr_b16 a[118:119], v249 offset:30720
    s_waitcnt lgkmcnt(12)
    v_mfma_f32_16x16x32_bf16 v[20:23], a[52:55], v[236:239], v[20:23]
    v_mfma_f32_16x16x32_bf16 v[24:27], a[64:67], v[236:239], v[24:27]
    v_mfma_f32_16x16x32_bf16 v[28:31], a[76:79], v[236:239], v[28:31]
    v_mfma_f32_16x16x32_bf16 v[32:35], a[88:91], v[236:239], v[32:35]
    v_mfma_f32_16x16x32_bf16 v[36:39], a[100:103], v[236:239], v[36:39]
    v_mfma_f32_16x16x32_bf16 v[40:43], a[112:115], v[236:239], v[40:43]
    s_waitcnt vmcnt(18)
    s_barrier
    buffer_load_dwordx4 a[36:39], v16, s[24:27], 0 offen offset:0
    buffer_load_dwordx4 a[40:43], v16, s[24:27], 0 offen offset:64
    buffer_load_dwordx4 a[44:47], v16, s[24:27], 0 offen offset:128
    s_cmp_eq_u32 s48, 0
    s_cbranch_scc1 L_kpath
    ds_read_b64_tr_b16 a[120:121], v215 offset:0
    ds_read_b64_tr_b16 a[122:123], v215 offset:3072
    ds_read_b64_tr_b16 a[132:133], v215 offset:8
    ds_read_b64_tr_b16 a[134:135], v215 offset:3080
    ds_read_b64_tr_b16 a[124:125], v215 offset:6144
    ds_read_b64_tr_b16 a[126:127], v215 offset:9216
    ds_read_b64_tr_b16 a[136:137], v215 offset:6152
    ds_read_b64_tr_b16 a[138:139], v215 offset:9224
    ds_read_b64_tr_b16 a[128:129], v215 offset:12288
    ds_read_b64_tr_b16 a[130:131], v215 offset:15360
    ds_read_b64_tr_b16 a[140:141], v215 offset:12296
    ds_read_b64_tr_b16 a[142:143], v215 offset:15368
    s_waitcnt lgkmcnt(12)
    v_mfma_f32_16x16x32_bf16 v[20:23], a[56:59], v[240:243], v[20:23]
    v_mfma_f32_16x16x32_bf16 v[24:27], a[68:71], v[240:243], v[24:27]
    v_mfma_f32_16x16x32_bf16 v[28:31], a[80:83], v[240:243], v[28:31]
    v_mfma_f32_16x16x32_bf16 v[32:35], a[92:95], v[240:243], v[32:35]
    v_mfma_f32_16x16x32_bf16 v[36:39], a[104:107], v[240:243], v[36:39]
    v_mfma_f32_16x16x32_bf16 v[40:43], a[116:119], v[240:243], v[40:43]
    s_nop 3
    v_cvt_pk_bf16_f32 v44, v20, v21
    v_cvt_pk_bf16_f32 v45, v22, v23
    v_cvt_pk_bf16_f32 v46, v24, v25
    v_cvt_pk_bf16_f32 v47, v26, v27
    v_cvt_pk_bf16_f32 v48, v28, v29
    v_cvt_pk_bf16_f32 v49, v30, v31
    v_cvt_pk_bf16_f32 v50, v32, v33
    v_cvt_pk_bf16_f32 v51, v34, v35
    v_cvt_pk_bf16_f32 v52, v36, v37
    v_cvt_pk_bf16_f32 v53, v38, v39
    v_cvt_pk_bf16_f32 v54, v40, v41
    v_cvt_pk_bf16_f32 v55, v42, v43
    s_waitcnt lgkmcnt(0)
    v_mfma_f32_16x16x32_bf16 v[72:75], v[44:47], a[120:123], 0
    v_mfma_f32_16x16x32_bf16 v[76:79], v[44:47], a[132:135], 0
    v_mfma_f32_16x16x32_bf16 v[72:75], v[48:51], a[124:127], v[72:75]
    v_mfma_f32_16x16x32_bf16 v[76:79], v[48:51], a[136:139], v[76:79]
    v_mfma_f32_16x16x32_bf16 v[72:75], v[52:55], a[128:131], v[72:75]
    v_mfma_f32_16x16x32_bf16 v[76:79], v[52:55], a[140:143], v[76:79]
    buffer_load_dword v19, v1, s[44:47], 0 offen sc1
    buffer_load_dword v18, v17, s[20:23], 0 offen sc1
    s_nop 4
    v_cvt_pk_bf16_f32 v72, v72, v73
    v_cvt_pk_bf16_f32 v73, v74, v75
    buffer_store_dwordx2 v[72:73], v214, s[20:23], 0 offen offset:0 sc1
    v_cvt_pk_bf16_f32 v76, v76, v77
    v_cvt_pk_bf16_f32 v77, v78, v79
    buffer_store_dwordx2 v[76:77], v214, s[20:23], 0 offen offset:1024 sc1
    s_branch L_published
L_kpath:
    s_waitcnt lgkmcnt(0)
    v_mfma_f32_16x16x32_bf16 v[20:23], a[56:59], v[240:243], v[20:23]
    v_mfma_f32_16x16x32_bf16 v[24:27], a[68:71], v[240:243], v[24:27]
    v_mfma_f32_16x16x32_bf16 v[28:31], a[80:83], v[240:243], v[28:31]
    v_mfma_f32_16x16x32_bf16 v[32:35], a[92:95], v[240:243], v[32:35]
    v_mfma_f32_16x16x32_bf16 v[36:39], a[104:107], v[240:243], v[36:39]
    v_mfma_f32_16x16x32_bf16 v[40:43], a[116:119], v[240:243], v[40:43]
    buffer_load_dword v19, v1, s[44:47], 0 offen sc1
    buffer_load_dword v18, v17, s[20:23], 0 offen sc1
    s_mov_b32 s50, 1041680192
    s_nop 0
    v_mul_f32 v20, s50, v20
    v_mul_f32 v21, s50, v21
    v_mul_f32 v22, s50, v22
    v_mul_f32 v23, s50, v23
    v_mul_f32 v24, s50, v24
    v_mul_f32 v25, s50, v25
    v_mul_f32 v26, s50, v26
    v_mul_f32 v27, s50, v27
    v_mul_f32 v28, s50, v28
    v_mul_f32 v29, s50, v29
    v_mul_f32 v30, s50, v30
    v_mul_f32 v31, s50, v31
    v_mul_f32 v32, s50, v32
    v_mul_f32 v33, s50, v33
    v_mul_f32 v34, s50, v34
    v_mul_f32 v35, s50, v35
    v_mul_f32 v36, s50, v36
    v_mul_f32 v37, s50, v37
    v_mul_f32 v38, s50, v38
    v_mul_f32 v39, s50, v39
    v_mul_f32 v40, s50, v40
    v_mul_f32 v41, s50, v41
    v_mul_f32 v42, s50, v42
    v_mul_f32 v43, s50, v43
    v_cvt_pk_bf16_f32 v44, v20, v21
    v_cvt_pk_bf16_f32 v45, v22, v23
    v_cvt_pk_bf16_f32 v46, v24, v25
    v_cvt_pk_bf16_f32 v47, v26, v27
    v_cvt_pk_bf16_f32 v48, v28, v29
    v_cvt_pk_bf16_f32 v49, v30, v31
    v_cvt_pk_bf16_f32 v50, v32, v33
    v_cvt_pk_bf16_f32 v51, v34, v35
    v_cvt_pk_bf16_f32 v52, v36, v37
    v_cvt_pk_bf16_f32 v53, v38, v39
    v_cvt_pk_bf16_f32 v54, v40, v41
    v_cvt_pk_bf16_f32 v55, v42, v43
    s_mov_b64 exec, s[96:97]
    buffer_store_dwordx4 v[44:47], v213, s[20:23], 0 offen offset:0 sc1
    buffer_store_dwordx4 v[48:51], v213, s[20:23], 0 offen offset:1024 sc1
    buffer_store_dwordx4 v[52:55], v213, s[20:23], 0 offen offset:2048 sc1
    ds_write_b128 v221, v[44:47] offset:768
    ds_write_b128 v221, v[48:51] offset:1024
    ds_write_b128 v221, v[52:55] offset:1280
    s_mov_b64 exec, -1
L_published:
    ds_read_b128 a[0:3], v254 offset:0
    ds_read_b128 a[4:7], v254 offset:64
    ds_read_b128 a[8:11], v254 offset:128
    ds_read_b128 a[12:15], v254 offset:3072
    ds_read_b128 a[16:19], v254 offset:3136
    ds_read_b128 a[20:23], v254 offset:3200
    ds_read_b128 a[24:27], v254 offset:6144
    ds_read_b128 a[28:31], v254 offset:6208
    ds_read_b128 a[32:35], v254 offset:6272
    s_bfe_u32 s37, s2, 0x20003
    s_waitcnt vmcnt(7) lgkmcnt(0)
    s_barrier
    ds_read_b64_tr_b16 a[48:49], v222 offset:0
    ds_read_b64_tr_b16 a[50:51], v222 offset:768
    ds_read_b64_tr_b16 a[60:61], v223 offset:32
    ds_read_b64_tr_b16 a[62:63], v223 offset:800
    ds_read_b64_tr_b16 a[72:73], v222 offset:64
    ds_read_b64_tr_b16 a[74:75], v222 offset:832
    ds_read_b64_tr_b16 a[84:85], v223 offset:96
    ds_read_b64_tr_b16 a[86:87], v223 offset:864
    ds_read_b64_tr_b16 a[96:97], v222 offset:128
    ds_read_b64_tr_b16 a[98:99], v222 offset:896
    ds_read_b64_tr_b16 a[108:109], v223 offset:160
    ds_read_b64_tr_b16 a[110:111], v223 offset:928
    ds_read_b64_tr_b16 a[52:53], v222 offset:6144
    ds_read_b64_tr_b16 a[54:55], v222 offset:6912
    ds_read_b64_tr_b16 a[64:65], v223 offset:6176
    ds_read_b64_tr_b16 a[66:67], v223 offset:6944
    ds_read_b64_tr_b16 a[76:77], v222 offset:6208
    ds_read_b64_tr_b16 a[78:79], v222 offset:6976
    ds_read_b64_tr_b16 a[88:89], v223 offset:6240
    ds_read_b64_tr_b16 a[90:91], v223 offset:7008
    ds_read_b64_tr_b16 a[100:101], v222 offset:6272
    ds_read_b64_tr_b16 a[102:103], v222 offset:7040
    ds_read_b64_tr_b16 a[112:113], v223 offset:6304
    ds_read_b64_tr_b16 a[114:115], v223 offset:7072
    s_waitcnt lgkmcnt(12)
    v_mfma_f32_16x16x32_bf16 v[20:23], a[48:51], a[0:3], 0
    v_mfma_f32_16x16x32_bf16 v[24:27], a[60:63], a[0:3], 0
    v_mfma_f32_16x16x32_bf16 v[28:31], a[72:75], a[0:3], 0
    v_mfma_f32_16x16x32_bf16 v[32:35], a[84:87], a[0:3], 0
    v_mfma_f32_16x16x32_bf16 v[36:39], a[96:99], a[0:3], 0
    v_mfma_f32_16x16x32_bf16 v[40:43], a[108:111], a[0:3], 0
    ds_read_b64_tr_b16 a[56:57], v222 offset:12288
    ds_read_b64_tr_b16 a[58:59], v222 offset:13056
    ds_read_b64_tr_b16 a[68:69], v223 offset:12320
    ds_read_b64_tr_b16 a[70:71], v223 offset:13088
    ds_read_b64_tr_b16 a[80:81], v222 offset:12352
    ds_read_b64_tr_b16 a[82:83], v222 offset:13120
    ds_read_b64_tr_b16 a[92:93], v223 offset:12384
    ds_read_b64_tr_b16 a[94:95], v223 offset:13152
    ds_read_b64_tr_b16 a[104:105], v222 offset:12416
    ds_read_b64_tr_b16 a[106:107], v222 offset:13184
    ds_read_b64_tr_b16 a[116:117], v223 offset:12448
    ds_read_b64_tr_b16 a[118:119], v223 offset:13216
    ds_read_b128 a[144:147], v203 offset:0
    ds_read_b128 a[148:151], v203 offset:256
    ds_read_b128 a[152:155], v203 offset:512
    s_waitcnt lgkmcnt(15)
    v_mfma_f32_16x16x32_bf16 v[20:23], a[52:55], a[4:7], v[20:23]
    v_mfma_f32_16x16x32_bf16 v[24:27], a[64:67], a[4:7], v[24:27]
    v_mfma_f32_16x16x32_bf16 v[28:31], a[76:79], a[4:7], v[28:31]
    v_mfma_f32_16x16x32_bf16 v[32:35], a[88:91], a[4:7], v[32:35]
    v_mfma_f32_16x16x32_bf16 v[36:39], a[100:103], a[4:7], v[36:39]
    v_mfma_f32_16x16x32_bf16 v[40:43], a[112:115], a[4:7], v[40:43]
    s_waitcnt lgkmcnt(3)
    v_mfma_f32_16x16x32_bf16 v[20:23], a[56:59], a[8:11], v[20:23]
    v_mfma_f32_16x16x32_bf16 v[24:27], a[68:71], a[8:11], v[24:27]
    v_mfma_f32_16x16x32_bf16 v[28:31], a[80:83], a[8:11], v[28:31]
    v_mfma_f32_16x16x32_bf16 v[32:35], a[92:95], a[8:11], v[32:35]
    v_mfma_f32_16x16x32_bf16 v[36:39], a[104:107], a[8:11], v[36:39]
    v_mfma_f32_16x16x32_bf16 v[40:43], a[116:119], a[8:11], v[40:43]
    s_waitcnt vmcnt(0)
    v_readfirstlane_b32 s69, v19
    s_mov_b32 s71, 0
    s_barrier
L_nonce:
    s_cmp_lg_u32 s69, 0
    s_cbranch_scc1 L_nonce_ok
    s_sleep 8
    buffer_load_dword v19, v1, s[44:47], 0 offen sc1
    s_add_u32 s71, s71, 1
    s_waitcnt vmcnt(0)
    v_readfirstlane_b32 s69, v19
    s_cmp_lt_u32 s71, 0x4000
    s_cbranch_scc1 L_nonce
L_nonce_ok:
    s_cmp_lg_u32 s48, 0
    s_cbranch_scc1 L_noflag
    v_mov_b32 v19, s69
    buffer_store_dword v19, v253, s[20:23], 0 offen sc1
L_noflag:
    v_cmp_ne_u32 s[64:65], s69, v18
    s_mov_b32 s70, 0
    s_wqm_b64 s[64:65], s[64:65]
    s_lshr_b64 s[66:67], s[64:65], 4
    s_or_b64 s[64:65], s[64:65], s[66:67]
    s_and_b64 s[60:61], s[60:61], s[64:65]
    s_andn2_b64 s[64:65], s[62:63], s[60:61]
    s_cbranch_scc0 L_f0
    s_ff1_i32_b64 s58, s[64:65]
    s_bitset0_b64 s[62:63], s58
    s_mul_i32 s57, s58, 6144
    s_add_u32 s57, s57, s49
    s_add_u32 s38, s16, s57
    s_addc_u32 s39, s17, 0
    s_add_u32 m0, s49, 0
    s_nop 0
    global_load_lds_dwordx4 v10, s[38:39] offset:0 sc1
    global_load_lds_dwordx4 v10, s[38:39] offset:1024 sc1
    global_load_lds_dwordx4 v10, s[38:39] offset:2048 sc1
    global_load_lds_dwordx4 v10, s[38:39] offset:3072 sc1
    s_add_u32 m0, s49, 4096
    s_nop 0
    global_load_lds_dwordx4 v11, s[38:39] offset:0 sc1
    global_load_lds_dwordx4 v11, s[38:39] offset:1024 sc1
    global_load_lds_dwordx4 v11, s[38:39] offset:2048 sc1
    global_load_lds_dwordx4 v11, s[38:39] offset:3072 sc1
    s_add_u32 m0, s49, 8192
    s_nop 0
    global_load_lds_dwordx4 v12, s[38:39] offset:0 sc1
    global_load_lds_dwordx4 v12, s[38:39] offset:1024 sc1
    global_load_lds_dwordx4 v12, s[38:39] offset:2048 sc1
    global_load_lds_dwordx4 v12, s[38:39] offset:3072 sc1
    s_mov_b32 s70, 1
L_f0:
    v_mfma_f32_16x16x32_bf16 v[44:47], a[48:51], a[12:15], 0
    v_mfma_f32_16x16x32_bf16 v[48:51], a[60:63], a[12:15], 0
    v_mfma_f32_16x16x32_bf16 v[52:55], a[72:75], a[12:15], 0
    v_mfma_f32_16x16x32_bf16 v[56:59], a[84:87], a[12:15], 0
    v_mfma_f32_16x16x32_bf16 v[60:63], a[96:99], a[12:15], 0
    v_cvt_pk_bf16_f32 v20, v20, v21
    v_accvgpr_write_b32 a0, v20
    v_mfma_f32_16x16x32_bf16 v[64:67], a[108:111], a[12:15], 0
    v_cvt_pk_bf16_f32 v22, v22, v23
    v_accvgpr_write_b32 a1, v22
    v_mfma_f32_16x16x32_bf16 v[44:47], a[52:55], a[16:19], v[44:47]
    v_cvt_pk_bf16_f32 v24, v24, v25
    v_accvgpr_write_b32 a2, v24
    v_mfma_f32_16x16x32_bf16 v[48:51], a[64:67], a[16:19], v[48:51]
    v_cvt_pk_bf16_f32 v26, v26, v27
    v_accvgpr_write_b32 a3, v26
    v_mfma_f32_16x16x32_bf16 v[52:55], a[76:79], a[16:19], v[52:55]
    v_cvt_pk_bf16_f32 v28, v28, v29
    v_accvgpr_write_b32 a4, v28
    v_mfma_f32_16x16x32_bf16 v[56:59], a[88:91], a[16:19], v[56:59]
    v_cvt_pk_bf16_f32 v30, v30, v31
    v_accvgpr_write_b32 a5, v30
    v_mfma_f32_16x16x32_bf16 v[60:63], a[100:103], a[16:19], v[60:63]
    v_cvt_pk_bf16_f32 v32, v32, v33
    v_accvgpr_write_b32 a6, v32
    v_mfma_f32_16x16x32_bf16 v[64:67], a[112:115], a[16:19], v[64:67]
    v_cvt_pk_bf16_f32 v34, v34, v35
    v_accvgpr_write_b32 a7, v34
    v_mfma_f32_16x16x32_bf16 v[44:47], a[56:59], a[20:23], v[44:47]
    v_cvt_pk_bf16_f32 v36, v36, v37
    v_accvgpr_write_b32 a8, v36
    v_mfma_f32_16x16x32_bf16 v[48:51], a[68:71], a[20:23], v[48:51]
    v_cvt_pk_bf16_f32 v38, v38, v39
    v_accvgpr_write_b32 a9, v38
    v_mfma_f32_16x16x32_bf16 v[52:55], a[80:83], a[20:23], v[52:55]
    v_cvt_pk_bf16_f32 v40, v40, v41
    v_accvgpr_write_b32 a10, v40
    v_mfma_f32_16x16x32_bf16 v[56:59], a[92:95], a[20:23], v[56:59]
    v_cvt_pk_bf16_f32 v42, v42, v43
    v_accvgpr_write_b32 a11, v42
    v_mfma_f32_16x16x32_bf16 v[60:63], a[104:107], a[20:23], v[60:63]
    v_mfma_f32_16x16x32_bf16 v[64:67], a[116:119], a[20:23], v[64:67]
    v_mfma_f32_16x16x32_bf16 v[20:23], a[48:51], a[24:27], 0
    v_mfma_f32_16x16x32_bf16 v[24:27], a[60:63], a[24:27], 0
    v_mfma_f32_16x16x32_bf16 v[28:31], a[72:75], a[24:27], 0
    v_mfma_f32_16x16x32_bf16 v[32:35], a[84:87], a[24:27], 0
    v_mfma_f32_16x16x32_bf16 v[36:39], a[96:99], a[24:27], 0
    v_cvt_pk_bf16_f32 v44, v44, v45
    v_accvgpr_write_b32 a12, v44
    v_mfma_f32_16x16x32_bf16 v[40:43], a[108:111], a[24:27], 0
    v_cvt_pk_bf16_f32 v46, v46, v47
    v_accvgpr_write_b32 a13, v46
    v_mfma_f32_16x16x32_bf16 v[20:23], a[52:55], a[28:31], v[20:23]
    v_cvt_pk_bf16_f32 v48, v48, v49
    v_accvgpr_write_b32 a14, v48
    v_mfma_f32_16x16x32_bf16 v[24:27], a[64:67], a[28:31], v[24:27]
    v_cvt_pk_bf16_f32 v50, v50, v51
    v_accvgpr_write_b32 a15, v50
    v_mfma_f32_16x16x32_bf16 v[28:31], a[76:79], a[28:31], v[28:31]
    v_cvt_pk_bf16_f32 v52, v52, v53
    v_accvgpr_write_b32 a16, v52
    v_mfma_f32_16x16x32_bf16 v[32:35], a[88:91], a[28:31], v[32:35]
    v_cvt_pk_bf16_f32 v54, v54, v55
    v_accvgpr_write_b32 a17, v54
    v_mfma_f32_16x16x32_bf16 v[36:39], a[100:103], a[28:31], v[36:39]
    v_cvt_pk_bf16_f32 v56, v56, v57
    v_accvgpr_write_b32 a18, v56
    v_mfma_f32_16x16x32_bf16 v[40:43], a[112:115], a[28:31], v[40:43]
    v_cvt_pk_bf16_f32 v58, v58, v59
    v_accvgpr_write_b32 a19, v58
    v_mfma_f32_16x16x32_bf16 v[20:23], a[56:59], a[32:35], v[20:23]
    v_cvt_pk_bf16_f32 v60, v60, v61
    v_accvgpr_write_b32 a20, v60
    v_mfma_f32_16x16x32_bf16 v[24:27], a[68:71], a[32:35], v[24:27]
    v_cvt_pk_bf16_f32 v62, v62, v63
    v_accvgpr_write_b32 a21, v62
    v_mfma_f32_16x16x32_bf16 v[28:31], a[80:83], a[32:35], v[28:31]
    v_cvt_pk_bf16_f32 v64, v64, v65
    v_accvgpr_write_b32 a22, v64
    v_mfma_f32_16x16x32_bf16 v[32:35], a[92:95], a[32:35], v[32:35]
    v_cvt_pk_bf16_f32 v66, v66, v67
    v_accvgpr_write_b32 a23, v66
    v_mfma_f32_16x16x32_bf16 v[36:39], a[104:107], a[32:35], v[36:39]
    v_mfma_f32_16x16x32_bf16 v[40:43], a[116:119], a[32:35], v[40:43]
    buffer_load_dword v18, v17, s[20:23], 0 offen sc1
    v_mfma_f32_16x16x32_bf16 v[44:47], a[48:51], a[36:39], 0
    v_mfma_f32_16x16x32_bf16 v[48:51], a[60:63], a[36:39], 0
    v_mfma_f32_16x16x32_bf16 v[52:55], a[72:75], a[36:39], 0
    v_mfma_f32_16x16x32_bf16 v[56:59], a[84:87], a[36:39], 0
    v_mfma_f32_16x16x32_bf16 v[60:63], a[96:99], a[36:39], 0
    v_cvt_pk_bf16_f32 v20, v20, v21
    v_accvgpr_write_b32 a24, v20
    v_mfma_f32_16x16x32_bf16 v[64:67], a[108:111], a[36:39], 0
    v_cvt_pk_bf16_f32 v22, v22, v23
    v_accvgpr_write_b32 a25, v22
    v_mfma_f32_16x16x32_bf16 v[44:47], a[52:55], a[40:43], v[44:47]
    v_cvt_pk_bf16_f32 v24, v24, v25
    v_accvgpr_write_b32 a26, v24
    v_mfma_f32_16x16x32_bf16 v[48:51], a[64:67], a[40:43], v[48:51]
    v_cvt_pk_bf16_f32 v26, v26, v27
    v_accvgpr_write_b32 a27, v26
    v_mfma_f32_16x16x32_bf16 v[52:55], a[76:79], a[40:43], v[52:55]
    v_cvt_pk_bf16_f32 v28, v28, v29
    v_accvgpr_write_b32 a28, v28
    v_mfma_f32_16x16x32_bf16 v[56:59], a[88:91], a[40:43], v[56:59]
    v_cvt_pk_bf16_f32 v30, v30, v31
    v_accvgpr_write_b32 a29, v30
    v_mfma_f32_16x16x32_bf16 v[60:63], a[100:103], a[40:43], v[60:63]
    v_cvt_pk_bf16_f32 v32, v32, v33
    v_accvgpr_write_b32 a30, v32
    v_mfma_f32_16x16x32_bf16 v[64:67], a[112:115], a[40:43], v[64:67]
    v_cvt_pk_bf16_f32 v34, v34, v35
    v_accvgpr_write_b32 a31, v34
    v_mfma_f32_16x16x32_bf16 v[44:47], a[56:59], a[44:47], v[44:47]
    v_cvt_pk_bf16_f32 v36, v36, v37
    v_accvgpr_write_b32 a32, v36
    v_mfma_f32_16x16x32_bf16 v[48:51], a[68:71], a[44:47], v[48:51]
    v_cvt_pk_bf16_f32 v38, v38, v39
    v_accvgpr_write_b32 a33, v38
    v_mfma_f32_16x16x32_bf16 v[52:55], a[80:83], a[44:47], v[52:55]
    v_cvt_pk_bf16_f32 v40, v40, v41
    v_accvgpr_write_b32 a34, v40
    v_mfma_f32_16x16x32_bf16 v[56:59], a[92:95], a[44:47], v[56:59]
    v_cvt_pk_bf16_f32 v42, v42, v43
    v_accvgpr_write_b32 a35, v42
    v_mfma_f32_16x16x32_bf16 v[60:63], a[104:107], a[44:47], v[60:63]
    v_mfma_f32_16x16x32_bf16 v[64:67], a[116:119], a[44:47], v[64:67]
    s_nop 3
    v_cvt_pk_bf16_f32 v44, v44, v45
    v_accvgpr_write_b32 a36, v44
    v_cvt_pk_bf16_f32 v46, v46, v47
    v_accvgpr_write_b32 a37, v46
    v_cvt_pk_bf16_f32 v48, v48, v49
    v_accvgpr_write_b32 a38, v48
    v_cvt_pk_bf16_f32 v50, v50, v51
    v_accvgpr_write_b32 a39, v50
    v_cvt_pk_bf16_f32 v52, v52, v53
    v_accvgpr_write_b32 a40, v52
    v_cvt_pk_bf16_f32 v54, v54, v55
    v_accvgpr_write_b32 a41, v54
    v_cvt_pk_bf16_f32 v56, v56, v57
    v_accvgpr_write_b32 a42, v56
    v_cvt_pk_bf16_f32 v58, v58, v59
    v_accvgpr_write_b32 a43, v58
    v_cvt_pk_bf16_f32 v60, v60, v61
    v_accvgpr_write_b32 a44, v60
    v_cvt_pk_bf16_f32 v62, v62, v63
    v_accvgpr_write_b32 a45, v62
    v_cvt_pk_bf16_f32 v64, v64, v65
    v_accvgpr_write_b32 a46, v64
    v_cvt_pk_bf16_f32 v66, v66, v67
    v_accvgpr_write_b32 a47, v66
    s_cmp_lg_u32 s70, 0
    s_cbranch_scc1 L_f1
    s_waitcnt vmcnt(0)
    v_cmp_ne_u32 s[64:65], s69, v18
    s_nop 0
    s_wqm_b64 s[64:65], s[64:65]
    s_lshr_b64 s[66:67], s[64:65], 4
    s_or_b64 s[64:65], s[64:65], s[66:67]
    s_and_b64 s[60:61], s[60:61], s[64:65]
    s_andn2_b64 s[64:65], s[62:63], s[60:61]
    s_cbranch_scc1 L_f1go
    buffer_load_dword v18, v17, s[20:23], 0 offen sc1
    s_branch L_f1
L_touch2:
    s_setpc_b64 s[64:65]
L_f1go:
    s_ff1_i32_b64 s58, s[64:65]
    s_bitset0_b64 s[62:63], s58
    s_mul_i32 s57, s58, 6144
    s_add_u32 s57, s57, s49
    s_add_u32 s38, s16, s57
    s_addc_u32 s39, s17, 0
    s_add_u32 m0, s49, 0
    s_nop 0
    global_load_lds_dwordx4 v10, s[38:39] offset:0 sc1
    global_load_lds_dwordx4 v10, s[38:39] offset:1024 sc1
    global_load_lds_dwordx4 v10, s[38:39] offset:2048 sc1
    global_load_lds_dwordx4 v10, s[38:39] offset:3072 sc1
    s_add_u32 m0, s49, 4096
    s_nop 0
    global_load_lds_dwordx4 v11, s[38:39] offset:0 sc1
    global_load_lds_dwordx4 v11, s[38:39] offset:1024 sc1
    global_load_lds_dwordx4 v11, s[38:39] offset:2048 sc1
    global_load_lds_dwordx4 v11, s[38:39] offset:3072 sc1
    s_add_u32 m0, s49, 8192
    s_nop 0
    global_load_lds_dwordx4 v12, s[38:39] offset:0 sc1
    global_load_lds_dwordx4 v12, s[38:39] offset:1024 sc1
    global_load_lds_dwordx4 v12, s[38:39] offset:2048 sc1
    global_load_lds_dwordx4 v12, s[38:39] offset:3072 sc1
    s_mov_b32 s70, 1
L_f1:
    s_waitcnt lgkmcnt(0)
    v_mfma_f32_16x16x32_bf16 v[72:75], a[144:147], a[0:3], 0
    v_mov_b32 v60, 0
    v_mfma_f32_16x16x32_bf16 v[76:79], a[144:147], a[12:15], 0
    v_mov_b32 v61, 0
    v_mfma_f32_16x16x32_bf16 v[80:83], a[144:147], a[24:27], 0
    v_mov_b32 v62, 0
    v_mfma_f32_16x16x32_bf16 v[84:87], a[144:147], a[36:39], 0
    v_mov_b32 v63, 0
    v_mfma_f32_16x16x32_bf16 v[72:75], a[148:151], a[4:7], v[72:75]
    v_mov_b32 v64, 0
    v_mfma_f32_16x16x32_bf16 v[76:79], a[148:151], a[16:19], v[76:79]
    v_mov_b32 v65, 0
    v_mfma_f32_16x16x32_bf16 v[80:83], a[148:151], a[28:31], v[80:83]
    v_mov_b32 v66, 0
    v_mfma_f32_16x16x32_bf16 v[84:87], a[148:151], a[40:43], v[84:87]
    v_mov_b32 v67, 0
    v_mfma_f32_16x16x32_bf16 v[72:75], a[152:155], a[8:11], v[72:75]
    v_mfma_f32_16x16x32_bf16 v[76:79], a[152:155], a[20:23], v[76:79]
    v_mfma_f32_16x16x32_bf16 v[80:83], a[152:155], a[32:35], v[80:83]
    v_mfma_f32_16x16x32_bf16 v[84:87], a[152:155], a[44:47], v[84:87]
    s_nop 1
    v_mov_b32 v2, v6
    v_mov_b32 v3, v7
    v_mov_b32 v4, v8
    v_mov_b32 v5, v9
    v_min3_f32 v72, -v72, -v73, -v74
    v_min3_f32 v72, v72, -v75, 0
    v_min3_f32 v76, -v76, -v77, -v78
    v_min3_f32 v76, v76, -v79, 0
    v_min3_f32 v80, -v80, -v81, -v82
    v_min3_f32 v80, v80, -v83, 0
    v_min3_f32 v84, -v84, -v85, -v86
    v_min3_f32 v84, v84, -v87, 0
    v_add_f32 v72, 0xc2800000, v72
    v_add_f32 v76, 0xc2800000, v76
    v_add_f32 v80, 0xc2800000, v80
    v_add_f32 v84, 0xc2800000, v84
    v_mov_b32 v73, v72
    v_mov_b32 v74, v72
    v_mov_b32 v75, v72
    v_mov_b32 v77, v76
    v_mov_b32 v78, v76
    v_mov_b32 v79, v76
    v_mov_b32 v81, v80
    v_mov_b32 v82, v80
    v_mov_b32 v83, v80
    v_mov_b32 v85, v84
    v_mov_b32 v86, v84
    v_mov_b32 v87, v84
    s_cmp_lg_u32 s70, 0
    s_cbranch_scc1 L_fetched
    s_mov_b32 s71, 0
    s_branch L_spin0_w
L_spin0:
    s_sleep 8
    buffer_load_dword v18, v17, s[20:23], 0 offen sc1
L_spin0_w:
    s_waitcnt vmcnt(0)
    v_cmp_ne_u32 s[64:65], s69, v18
    s_nop 0
    s_wqm_b64 s[64:65], s[64:65]
    s_lshr_b64 s[66:67], s[64:65], 4
    s_or_b64 s[64:65], s[64:65], s[66:67]
    s_and_b64 s[60:61], s[60:61], s[64:65]
    s_andn2_b64 s[64:65], s[62:63], s[60:61]
    s_cbranch_scc1 L_spin0_ok
    s_add_u32 s71, s71, 1
    s_cmp_lt_u32 s71, 0x4000
    s_cbranch_scc1 L_spin0
    s_mov_b64 s[60:61], 0
    s_andn2_b64 s[64:65], s[62:63], s[60:61]
L_spin0_ok:
L_restart:
    s_ff1_i32_b64 s58, s[64:65]
    s_bitset0_b64 s[62:63], s58
    s_mul_i32 s57, s58, 6144
    s_add_u32 s57, s57, s49
    s_add_u32 s38, s16, s57
    s_addc_u32 s39, s17, 0
    s_add_u32 m0, s49, 0
    s_nop 0
    global_load_lds_dwordx4 v10, s[38:39] offset:0 sc1
    global_load_lds_dwordx4 v10, s[38:39] offset:1024 sc1
    global_load_lds_dwordx4 v10, s[38:39] offset:2048 sc1
    global_load_lds_dwordx4 v10, s[38:39] offset:3072 sc1
    s_add_u32 m0, s49, 4096
    s_nop 0
    global_load_lds_dwordx4 v11, s[38:39] offset:0 sc1
    global_load_lds_dwordx4 v11, s[38:39] offset:1024 sc1
    global_load_lds_dwordx4 v11, s[38:39] offset:2048 sc1
    global_load_lds_dwordx4 v11, s[38:39] offset:3072 sc1
    s_add_u32 m0, s49, 8192
    s_nop 0
    global_load_lds_dwordx4 v12, s[38:39] offset:0 sc1
    global_load_lds_dwordx4 v12, s[38:39] offset:1024 sc1
    global_load_lds_dwordx4 v12, s[38:39] offset:2048 sc1
    global_load_lds_dwordx4 v12, s[38:39] offset:3072 sc1
    s_mov_b32 s70, 1
L_fetched:
    buffer_load_dword v18, v17, s[20:23], 0 offen sc1
    s_waitcnt vmcnt(7)
    s_barrier
    ds_read_b128 a[48:51], v2 offset:0
    ds_read_b128 a[52:55], v2 offset:1024
    ds_read_b128 a[56:59], v2 offset:2048
    ds_read_b128 a[60:63], v2 offset:3072
    ds_read_b128 a[64:67], v2 offset:4096
    ds_read_b128 a[68:71], v2 offset:5120
    ds_read_b128 a[72:75], v3 offset:0
    ds_read_b128 a[76:79], v3 offset:1024
    ds_read_b128 a[80:83], v3 offset:2048
    ds_read_b128 a[84:87], v3 offset:3072
    ds_read_b128 a[88:91], v3 offset:4096
    ds_read_b128 a[92:95], v3 offset:5120
    v_lshlrev_b32 v241, 2, v0
    v_add_u32 v241, 148480, v241
    v_mov_b32 v240, 255
    v_lshlrev_b32 v243, 4, v0
    v_and_b32 v243, 0x3f0, v243
    v_add_u32 v243, 148480, v243
    ds_write_b32 v241, v240
    s_cmp_eq_u32 s37, 0
    s_cbranch_scc1 L_q13
    s_waitcnt lgkmcnt(10)
    v_mfma_f32_16x16x32_bf16 v[20:23], a[48:51], a[0:3], v[72:75]
    v_mfma_f32_16x16x32_bf16 v[20:23], a[52:55], a[4:7], v[20:23]
    v_mfma_f32_16x16x32_bf16 v[20:23], a[56:59], a[8:11], v[20:23]
    s_waitcnt lgkmcnt(7)
    v_mfma_f32_16x16x32_bf16 v[24:27], a[60:63], a[0:3], v[72:75]
    v_mfma_f32_16x16x32_bf16 v[24:27], a[64:67], a[4:7], v[24:27]
    v_mfma_f32_16x16x32_bf16 v[24:27], a[68:71], a[8:11], v[24:27]
    s_branch L_q0done
L_q13:
    s_waitcnt lgkmcnt(10)
    v_mfma_f32_16x16x32_bf16 v[36:39], a[48:51], a[36:39], v[84:87]
    v_mfma_f32_16x16x32_bf16 v[36:39], a[52:55], a[40:43], v[36:39]
    v_mfma_f32_16x16x32_bf16 v[36:39], a[56:59], a[44:47], v[36:39]
    s_waitcnt lgkmcnt(7)
    v_mfma_f32_16x16x32_bf16 v[40:43], a[60:63], a[36:39], v[84:87]
    v_mfma_f32_16x16x32_bf16 v[40:43], a[64:67], a[40:43], v[40:43]
    v_mfma_f32_16x16x32_bf16 v[40:43], a[68:71], a[44:47], v[40:43]
L_q0done:
    s_andn2_b64 s[64:65], s[62:63], s[60:61]
    s_cbranch_scc1 L_spin1_ok
    s_mov_b32 s71, 0
    s_branch L_spin1_w
L_spin1:
    s_sleep 8
    buffer_load_dword v18, v17, s[20:23], 0 offen sc1
L_spin1_w:
    s_waitcnt vmcnt(0)
    v_cmp_ne_u32 s[64:65], s69, v18
    s_nop 0
    s_wqm_b64 s[64:65], s[64:65]
    s_lshr_b64 s[66:67], s[64:65], 4
    s_or_b64 s[64:65], s[64:65], s[66:67]
    s_and_b64 s[60:61], s[60:61], s[64:65]
    s_andn2_b64 s[64:65], s[62:63], s[60:61]
    s_cbranch_scc1 L_spin1_ok
    s_add_u32 s71, s71, 1
    s_cmp_lt_u32 s71, 0x4000
    s_cbranch_scc1 L_spin1
    s_mov_b64 s[60:61], 0
    s_andn2_b64 s[64:65], s[62:63], s[60:61]
L_spin1_ok:
    s_ff1_i32_b64 s58, s[64:65]
    s_bitset0_b64 s[62:63], s58
    s_mul_i32 s57, s58, 6144
    s_add_u32 s57, s57, s49
    s_add_u32 s38, s16, s57
    s_addc_u32 s39, s17, 0
    s_add_u32 s56, s49, 49152
    s_mov_b32 m0, s56
    s_mov_b64 vcc, 0
    global_load_lds_dwordx4 v10, s[38:39] offset:0 sc1
    global_load_lds_dwordx4 v10, s[38:39] offset:1024 sc1
    global_load_lds_dwordx4 v10, s[38:39] offset:2048 sc1
    global_load_lds_dwordx4 v10, s[38:39] offset:3072 sc1
    s_waitcnt vmcnt(4) lgkmcnt(0)
    s_barrier
    ds_read_b128 a[144:147], v2 offset:6144
    ds_read_b128 a[148:151], v2 offset:7168
    ds_read_b128 a[152:155], v2 offset:8192
    ds_read_b128 a[156:159], v2 offset:9216
    ds_read_b128 a[160:163], v2 offset:10240
    ds_read_b128 a[164:167], v2 offset:11264
    s_cmp_eq_u32 s37, 0
    s_cbranch_scc1 L_loop13
    s_add_u32 m0, s56, 4096
    s_nop 0
    global_load_lds_dwordx4 v11, s[38:39] offset:0 sc1
    global_load_lds_dwordx4 v11, s[38:39] offset:1024 sc1
    global_load_lds_dwordx4 v11, s[38:39] offset:2048 sc1
    global_load_lds_dwordx4 v11, s[38:39] offset:3072 sc1
    s_branch L_loop12
.p2align 6
L_back13:
    v_mfma_f32_16x16x32_bf16 v[28:31], a[120:123], a[24:27], v[80:83]
    v_exp_f32 v20, v20
    v_mfma_f32_16x16x32_bf16 v[28:31], a[124:127], a[28:31], v[28:31]
    v_exp_f32 v21, v21
    v_mfma_f32_16x16x32_bf16 v[28:31], a[128:131], a[32:35], v[28:31]
    ds_read_b128 a[88:91], v3 offset:4096
    v_cvt_pk_bf16_f32 v60, v20, v21
    v_mfma_f32_16x16x32_bf16 v[32:35], a[132:135], a[24:27], v[80:83]
    v_exp_f32 v22, v22
    v_mfma_f32_16x16x32_bf16 v[32:35], a[136:139], a[28:31], v[32:35]
    v_exp_f32 v23, v23
    v_mfma_f32_16x16x32_bf16 v[32:35], a[140:143], a[32:35], v[32:35]
    ds_read_b128 a[92:95], v3 offset:5120
    v_cvt_pk_bf16_f32 v61, v22, v23
    v_mfma_f32_16x16x32_bf16 v[116:119], a[192:195], v[52:55], v[116:119]
    v_exp_f32 v24, v24
    v_mfma_f32_16x16x32_bf16 v[116:119], a[216:219], v[56:59], v[116:119]
    v_exp_f32 v25, v25
    v_mfma_f32_16x16x32_bf16 v[120:123], a[196:199], v[52:55], v[120:123]
    ds_read_b128 a[144:147], v2 offset:6144
    v_cvt_pk_bf16_f32 v62, v24, v25
    v_mfma_f32_16x16x32_bf16 v[120:123], a[220:223], v[56:59], v[120:123]
    v_exp_f32 v26, v26
    v_mfma_f32_16x16x32_bf16 v[124:127], a[200:203], v[52:55], v[124:127]
    v_exp_f32 v27, v27
    v_mfma_f32_16x16x32_bf16 v[124:127], a[224:227], v[56:59], v[124:127]
    s_waitcnt lgkmcnt(1)
    ds_read_b128 a[148:151], v2 offset:7168
    v_cvt_pk_bf16_f32 v63, v26, v27
    v_mfma_f32_16x16x32_bf16 v[36:39], a[48:51], a[36:39], v[84:87]
    s_mov_b32 s54, s52
    v_exp_f32 v28, v28
    v_mfma_f32_16x16x32_bf16 v[36:39], a[52:55], a[40:43], v[36:39]
    s_add_u32 s59, s53, 49152
    v_exp_f32 v29, v29
    v_mfma_f32_16x16x32_bf16 v[36:39], a[56:59], a[44:47], v[36:39]
    ds_read_b128 a[152:155], v2 offset:8192
    v_cvt_pk_bf16_f32 v64, v28, v29
    v_mfma_f32_16x16x32_bf16 v[40:43], a[60:63], a[36:39], v[84:87]
    s_cmp_eq_u32 s59, 147456
    v_exp_f32 v30, v30
    v_mfma_f32_16x16x32_bf16 v[40:43], a[64:67], a[40:43], v[40:43]
    s_mov_b32 s52, s53
    v_exp_f32 v31, v31
    v_mfma_f32_16x16x32_bf16 v[40:43], a[68:71], a[44:47], v[40:43]
    ds_read_b128 a[156:159], v2 offset:9216
    v_cvt_pk_bf16_f32 v65, v30, v31
    v_mfma_f32_16x16x32_bf16 v[128:131], a[204:207], v[52:55], v[128:131]
    s_cselect_b32 s53, 0, s59
    v_exp_f32 v32, v32
    v_mfma_f32_16x16x32_bf16 v[128:131], a[228:231], v[56:59], v[128:131]
    v_exp_f32 v33, v33
    v_mfma_f32_16x16x32_bf16 v[132:135], a[208:211], v[52:55], v[132:135]
    ds_read_b128 a[160:163], v2 offset:10240
    v_cvt_pk_bf16_f32 v66, v32, v33
    v_mfma_f32_16x16x32_bf16 v[132:135], a[232:235], v[56:59], v[132:135]
    v_exp_f32 v34, v34
    v_mfma_f32_16x16x32_bf16 v[136:139], a[212:215], v[52:55], v[136:139]
    v_exp_f32 v35, v35
    v_mfma_f32_16x16x32_bf16 v[136:139], a[236:239], v[56:59], v[136:139]
    ds_read_b128 a[164:167], v2 offset:11264
    v_cvt_pk_bf16_f32 v67, v34, v35
    v_smfmac_f32_16x16x64_bf16 v[140:143], a[244:247], v[52:59], v255
    s_cbranch_vccnz L_sk13_1
    global_load_lds_dwordx4 v10, s[38:39] offset:2048 sc1
    global_load_lds_dwordx4 v10, s[38:39] offset:3072 sc1
L_sk13_1:
L_loop13:
    v_mfma_f32_16x16x32_bf16 v[20:23], a[48:51], a[0:3], v[72:75]
    v_exp_f32 v36, v36
    v_mfma_f32_16x16x32_bf16 v[20:23], a[52:55], a[4:7], v[20:23]
    v_exp_f32 v37, v37
    v_mfma_f32_16x16x32_bf16 v[20:23], a[56:59], a[8:11], v[20:23]
    ds_read_b128 a[168:171], v3 offset:6144
    v_cvt_pk_bf16_f32 v68, v36, v37
    v_mfma_f32_16x16x32_bf16 v[24:27], a[60:63], a[0:3], v[72:75]
    v_exp_f32 v38, v38
    v_mfma_f32_16x16x32_bf16 v[24:27], a[64:67], a[4:7], v[24:27]
    v_exp_f32 v39, v39
    v_mfma_f32_16x16x32_bf16 v[24:27], a[68:71], a[8:11], v[24:27]
    ds_read_b128 a[172:175], v3 offset:7168
    v_cvt_pk_bf16_f32 v69, v38, v39
    v_mfma_f32_16x16x32_bf16 v[144:147], a[192:195], v[60:63], v[144:147]
    v_exp_f32 v40, v40
    v_mfma_f32_16x16x32_bf16 v[144:147], a[216:219], v[64:67], v[144:147]
    v_exp_f32 v41, v41
    v_mfma_f32_16x16x32_bf16 v[148:151], a[196:199], v[60:63], v[148:151]
    ds_read_b128 a[176:179], v3 offset:8192
    v_cvt_pk_bf16_f32 v70, v40, v41
    v_mfma_f32_16x16x32_bf16 v[148:151], a[220:223], v[64:67], v[148:151]
    v_exp_f32 v42, v42
    v_mfma_f32_16x16x32_bf16 v[152:155], a[200:203], v[60:63], v[152:155]
    v_exp_f32 v43, v43
    v_mfma_f32_16x16x32_bf16 v[152:155], a[224:227], v[64:67], v[152:155]
    ds_read_b128 a[180:183], v3 offset:9216
    v_cvt_pk_bf16_f32 v71, v42, v43
    v_mfma_f32_16x16x32_bf16 v[28:31], a[72:75], a[0:3], v[72:75]
    v_exp_f32 v20, v20
    v_mfma_f32_16x16x32_bf16 v[28:31], a[76:79], a[4:7], v[28:31]
    v_exp_f32 v21, v21
    v_mfma_f32_16x16x32_bf16 v[28:31], a[80:83], a[8:11], v[28:31]
    ds_read_b128 a[184:187], v3 offset:10240
    v_cvt_pk_bf16_f32 v44, v20, v21
    v_mfma_f32_16x16x32_bf16 v[32:35], a[84:87], a[0:3], v[72:75]
    v_exp_f32 v22, v22
    v_mfma_f32_16x16x32_bf16 v[32:35], a[88:91], a[4:7], v[32:35]
    v_exp_f32 v23, v23
    v_mfma_f32_16x16x32_bf16 v[32:35], a[92:95], a[8:11], v[32:35]
    ds_read_b128 a[188:191], v3 offset:11264
    v_cvt_pk_bf16_f32 v45, v22, v23
    v_mfma_f32_16x16x32_bf16 v[156:159], a[204:207], v[60:63], v[156:159]
    v_exp_f32 v24, v24
    v_mfma_f32_16x16x32_bf16 v[156:159], a[228:231], v[64:67], v[156:159]
    v_exp_f32 v25, v25
    v_mfma_f32_16x16x32_bf16 v[160:163], a[208:211], v[60:63], v[160:163]
    v_cvt_pk_bf16_f32 v46, v24, v25
    v_add_u32 v4, s54, v8
    v_mfma_f32_16x16x32_bf16 v[160:163], a[232:235], v[64:67], v[160:163]
    v_exp_f32 v26, v26
    v_mfma_f32_16x16x32_bf16 v[164:167], a[212:215], v[60:63], v[164:167]
    v_exp_f32 v27, v27
    v_mfma_f32_16x16x32_bf16 v[164:167], a[236:239], v[64:67], v[164:167]
    s_add_u32 m0, s56, 4096
    v_cvt_pk_bf16_f32 v47, v26, v27
    v_add_u32 v5, s54, v9
    v_smfmac_f32_16x16x64_bf16 v[168:171], a[244:247], v[60:67], v255
    s_cbranch_vccnz L_sk13_2
    global_load_lds_dwordx4 v11, s[38:39] offset:0 sc1
    global_load_lds_dwordx4 v11, s[38:39] offset:1024 sc1
    global_load_lds_dwordx4 v11, s[38:39] offset:2048 sc1
    global_load_lds_dwordx4 v11, s[38:39] offset:3072 sc1
L_sk13_2:
    v_mfma_f32_16x16x32_bf16 v[20:23], a[48:51], a[12:15], v[76:79]
    s_waitcnt lgkmcnt(0)
    v_exp_f32 v28, v28
    v_mfma_f32_16x16x32_bf16 v[20:23], a[52:55], a[16:19], v[20:23]
    v_exp_f32 v29, v29
    v_mfma_f32_16x16x32_bf16 v[20:23], a[56:59], a[20:23], v[20:23]
    v_cvt_pk_bf16_f32 v48, v28, v29
    v_add_u32 v2, s52, v6
    v_mfma_f32_16x16x32_bf16 v[24:27], a[60:63], a[12:15], v[76:79]
    v_exp_f32 v30, v30
    v_mfma_f32_16x16x32_bf16 v[24:27], a[64:67], a[16:19], v[24:27]
    v_exp_f32 v31, v31
    v_mfma_f32_16x16x32_bf16 v[24:27], a[68:71], a[20:23], v[24:27]
    v_cvt_pk_bf16_f32 v49, v30, v31
    v_add_u32 v3, s52, v7
    v_mfma_f32_16x16x32_bf16 v[172:175], a[144:147], v[68:71], v[172:175]
    v_exp_f32 v32, v32
    v_mfma_f32_16x16x32_bf16 v[176:179], a[148:151], v[68:71], v[176:179]
    v_exp_f32 v33, v33
    v_mfma_f32_16x16x32_bf16 v[180:183], a[152:155], v[68:71], v[180:183]
    ds_read_b128 a[96:99], v4 offset:0
    v_cvt_pk_bf16_f32 v50, v32, v33
    v_mfma_f32_16x16x32_bf16 v[184:187], a[156:159], v[68:71], v[184:187]
    v_exp_f32 v34, v34
    v_mfma_f32_16x16x32_bf16 v[188:191], a[160:163], v[68:71], v[188:191]
    v_exp_f32 v35, v35
    v_mfma_f32_16x16x32_bf16 v[192:195], a[164:167], v[68:71], v[192:195]
    s_add_u32 m0, s56, 8192
    ds_read_b128 a[100:103], v4 offset:1024
    v_cvt_pk_bf16_f32 v51, v34, v35
    v_mfma_f32_16x16x32_bf16 v[196:199], a[240:243], v[68:71], v[196:199]
    s_cbranch_vccnz L_sk13_3
    global_load_lds_dwordx4 v12, s[38:39] offset:0 sc1
    global_load_lds_dwordx4 v12, s[38:39] offset:1024 sc1
    global_load_lds_dwordx4 v12, s[38:39] offset:2048 sc1
    global_load_lds_dwordx4 v12, s[38:39] offset:3072 sc1
L_sk13_3:
    buffer_load_dword v18, v17, s[20:23], 0 offen sc1
    v_mfma_f32_16x16x32_bf16 v[28:31], a[72:75], a[12:15], v[76:79]
    v_exp_f32 v20, v20
    v_mfma_f32_16x16x32_bf16 v[28:31], a[76:79], a[16:19], v[28:31]
    v_exp_f32 v21, v21
    v_mfma_f32_16x16x32_bf16 v[28:31], a[80:83], a[20:23], v[28:31]
    ds_read_b128 a[104:107], v4 offset:2048
    v_cvt_pk_bf16_f32 v52, v20, v21
    v_mfma_f32_16x16x32_bf16 v[32:35], a[84:87], a[12:15], v[76:79]
    v_exp_f32 v22, v22
    v_mfma_f32_16x16x32_bf16 v[32:35], a[88:91], a[16:19], v[32:35]
    v_exp_f32 v23, v23
    v_mfma_f32_16x16x32_bf16 v[32:35], a[92:95], a[20:23], v[32:35]
    ds_read_b128 a[108:111], v4 offset:3072
    v_cvt_pk_bf16_f32 v53, v22, v23
    v_mfma_f32_16x16x32_bf16 v[88:91], a[144:147], v[44:47], v[88:91]
    v_exp_f32 v24, v24
    v_mfma_f32_16x16x32_bf16 v[88:91], a[168:171], v[48:51], v[88:91]
    v_exp_f32 v25, v25
    v_mfma_f32_16x16x32_bf16 v[92:95], a[148:151], v[44:47], v[92:95]
    ds_read_b128 a[112:115], v4 offset:4096
    v_cvt_pk_bf16_f32 v54, v24, v25
    v_mfma_f32_16x16x32_bf16 v[92:95], a[172:175], v[48:51], v[92:95]
    v_exp_f32 v26, v26
    v_mfma_f32_16x16x32_bf16 v[96:99], a[152:155], v[44:47], v[96:99]
    v_exp_f32 v27, v27
    v_mfma_f32_16x16x32_bf16 v[96:99], a[176:179], v[48:51], v[96:99]
    ds_read_b128 a[116:119], v4 offset:5120
    v_cvt_pk_bf16_f32 v55, v26, v27
    v_mfma_f32_16x16x32_bf16 v[20:23], a[48:51], a[24:27], v[80:83]
    v_exp_f32 v28, v28
    v_mfma_f32_16x16x32_bf16 v[20:23], a[52:55], a[28:31], v[20:23]
    v_exp_f32 v29, v29
    v_mfma_f32_16x16x32_bf16 v[20:23], a[56:59], a[32:35], v[20:23]
    ds_read_b128 a[120:123], v5 offset:0
    v_cvt_pk_bf16_f32 v56, v28, v29
    v_mfma_f32_16x16x32_bf16 v[24:27], a[60:63], a[24:27], v[80:83]
    v_exp_f32 v30, v30
    v_mfma_f32_16x16x32_bf16 v[24:27], a[64:67], a[28:31], v[24:27]
    v_exp_f32 v31, v31
    v_mfma_f32_16x16x32_bf16 v[24:27], a[68:71], a[32:35], v[24:27]
    ds_read_b128 a[124:127], v5 offset:1024
    v_cvt_pk_bf16_f32 v57, v30, v31
    v_mfma_f32_16x16x32_bf16 v[100:103], a[156:159], v[44:47], v[100:103]
    v_exp_f32 v32, v32
    v_mfma_f32_16x16x32_bf16 v[100:103], a[180:183], v[48:51], v[100:103]
    v_exp_f32 v33, v33
    v_mfma_f32_16x16x32_bf16 v[104:107], a[160:163], v[44:47], v[104:107]
    ds_read_b128 a[128:131], v5 offset:2048
    v_cvt_pk_bf16_f32 v58, v32, v33
    v_mfma_f32_16x16x32_bf16 v[104:107], a[184:187], v[48:51], v[104:107]
    v_exp_f32 v34, v34
    v_mfma_f32_16x16x32_bf16 v[108:111], a[164:167], v[44:47], v[108:111]
    v_exp_f32 v35, v35
    v_mfma_f32_16x16x32_bf16 v[108:111], a[188:191], v[48:51], v[108:111]
    ds_read_b128 a[132:135], v5 offset:3072
    v_cvt_pk_bf16_f32 v59, v34, v35
    v_smfmac_f32_16x16x64_bf16 v[112:115], a[244:247], v[44:51], v255
    v_mfma_f32_16x16x32_bf16 v[28:31], a[72:75], a[24:27], v[80:83]
    v_exp_f32 v20, v20
    v_mfma_f32_16x16x32_bf16 v[28:31], a[76:79], a[28:31], v[28:31]
    v_exp_f32 v21, v21
    v_mfma_f32_16x16x32_bf16 v[28:31], a[80:83], a[32:35], v[28:31]
    ds_read_b128 a[136:139], v5 offset:4096
    v_cvt_pk_bf16_f32 v60, v20, v21
    v_mfma_f32_16x16x32_bf16 v[32:35], a[84:87], a[24:27], v[80:83]
    v_exp_f32 v22, v22
    v_mfma_f32_16x16x32_bf16 v[32:35], a[88:91], a[28:31], v[32:35]
    v_exp_f32 v23, v23
    v_mfma_f32_16x16x32_bf16 v[32:35], a[92:95], a[32:35], v[32:35]
    ds_read_b128 a[140:143], v5 offset:5120
    v_cvt_pk_bf16_f32 v61, v22, v23
    v_mfma_f32_16x16x32_bf16 v[116:119], a[144:147], v[52:55], v[116:119]
    v_exp_f32 v24, v24
    v_mfma_f32_16x16x32_bf16 v[116:119], a[168:171], v[56:59], v[116:119]
    v_exp_f32 v25, v25
    v_mfma_f32_16x16x32_bf16 v[120:123], a[148:151], v[52:55], v[120:123]
    ds_read_b128 a[192:195], v4 offset:6144
    v_cvt_pk_bf16_f32 v62, v24, v25
    v_mfma_f32_16x16x32_bf16 v[120:123], a[172:175], v[56:59], v[120:123]
    v_exp_f32 v26, v26
    v_mfma_f32_16x16x32_bf16 v[124:127], a[152:155], v[52:55], v[124:127]
    v_exp_f32 v27, v27
    v_mfma_f32_16x16x32_bf16 v[124:127], a[176:179], v[56:59], v[124:127]
    s_waitcnt lgkmcnt(1)
    ds_read_b128 a[196:199], v4 offset:7168
    v_cvt_pk_bf16_f32 v63, v26, v27
    v_mfma_f32_16x16x32_bf16 v[20:23], a[96:99], a[0:3], v[72:75]
    v_exp_f32 v28, v28
    v_mfma_f32_16x16x32_bf16 v[20:23], a[100:103], a[4:7], v[20:23]
    v_exp_f32 v29, v29
    v_mfma_f32_16x16x32_bf16 v[20:23], a[104:107], a[8:11], v[20:23]
    ds_read_b128 a[200:203], v4 offset:8192
    v_cvt_pk_bf16_f32 v64, v28, v29
    v_mfma_f32_16x16x32_bf16 v[24:27], a[108:111], a[0:3], v[72:75]
    v_exp_f32 v30, v30
    v_mfma_f32_16x16x32_bf16 v[24:27], a[112:115], a[4:7], v[24:27]
    v_exp_f32 v31, v31
    v_mfma_f32_16x16x32_bf16 v[24:27], a[116:119], a[8:11], v[24:27]
    ds_read_b128 a[204:207], v4 offset:9216
    v_cvt_pk_bf16_f32 v65, v30, v31
    v_mfma_f32_16x16x32_bf16 v[128:131], a[156:159], v[52:55], v[128:131]
    v_exp_f32 v32, v32
    v_mfma_f32_16x16x32_bf16 v[128:131], a[180:183], v[56:59], v[128:131]
    v_exp_f32 v33, v33
    v_mfma_f32_16x16x32_bf16 v[132:135], a[160:163], v[52:55], v[132:135]
    ds_read_b128 a[208:211], v4 offset:10240
    v_cvt_pk_bf16_f32 v66, v32, v33
    v_mfma_f32_16x16x32_bf16 v[132:135], a[184:187], v[56:59], v[132:135]
    v_exp_f32 v34, v34
    v_mfma_f32_16x16x32_bf16 v[136:139], a[164:167], v[52:55], v[136:139]
    v_exp_f32 v35, v35
    v_mfma_f32_16x16x32_bf16 v[136:139], a[188:191], v[56:59], v[136:139]
    ds_read_b128 a[212:215], v4 offset:11264
    v_cvt_pk_bf16_f32 v67, v34, v35
    v_smfmac_f32_16x16x64_bf16 v[140:143], a[244:247], v[52:59], v255
    v_mov_b32 v240, s55
    v_mfma_f32_16x16x32_bf16 v[28:31], a[120:123], a[0:3], v[72:75]
    v_exp_f32 v20, v20
    v_mfma_f32_16x16x32_bf16 v[28:31], a[124:127], a[4:7], v[28:31]
    v_exp_f32 v21, v21
    v_mfma_f32_16x16x32_bf16 v[28:31], a[128:131], a[8:11], v[28:31]
    ds_read_b128 a[216:219], v5 offset:6144
    v_cvt_pk_bf16_f32 v44, v20, v21
    v_mfma_f32_16x16x32_bf16 v[32:35], a[132:135], a[0:3], v[72:75]
    s_waitcnt vmcnt(0)
    v_exp_f32 v22, v22
    v_mfma_f32_16x16x32_bf16 v[32:35], a[136:139], a[4:7], v[32:35]
    v_exp_f32 v23, v23
    v_mfma_f32_16x16x32_bf16 v[32:35], a[140:143], a[8:11], v[32:35]
    ds_write_b32 v241, v240
    ds_read_b128 a[220:223], v5 offset:7168
    v_cvt_pk_bf16_f32 v45, v22, v23
    v_mfma_f32_16x16x32_bf16 v[144:147], a[144:147], v[60:63], v[144:147]
    v_exp_f32 v24, v24
    v_mfma_f32_16x16x32_bf16 v[144:147], a[168:171], v[64:67], v[144:147]
    v_exp_f32 v25, v25
    v_mfma_f32_16x16x32_bf16 v[148:151], a[148:151], v[60:63], v[148:151]
    ds_read_b128 a[224:227], v5 offset:8192
    v_cvt_pk_bf16_f32 v46, v24, v25
    v_mfma_f32_16x16x32_bf16 v[148:151], a[172:175], v[64:67], v[148:151]
    v_exp_f32 v26, v26
    v_mfma_f32_16x16x32_bf16 v[152:155], a[152:155], v[60:63], v[152:155]
    v_exp_f32 v27, v27
    v_mfma_f32_16x16x32_bf16 v[152:155], a[176:179], v[64:67], v[152:155]
    ds_read_b128 a[228:231], v5 offset:9216
    v_cvt_pk_bf16_f32 v47, v26, v27
    v_mfma_f32_16x16x32_bf16 v[20:23], a[96:99], a[12:15], v[76:79]
    s_cmp_lt_u32 s55, 2
    v_exp_f32 v28, v28
    v_mfma_f32_16x16x32_bf16 v[20:23], a[100:103], a[16:19], v[20:23]
    s_cselect_b64 vcc, -1, 0
    v_exp_f32 v29, v29
    v_mfma_f32_16x16x32_bf16 v[20:23], a[104:107], a[20:23], v[20:23]
    ds_read_b32 v242, v243
    ds_read_b128 a[232:235], v5 offset:10240
    v_cvt_pk_bf16_f32 v48, v28, v29
    v_mfma_f32_16x16x32_bf16 v[24:27], a[108:111], a[12:15], v[76:79]
    s_add_u32 s56, s53, s49
    v_exp_f32 v30, v30
    v_mfma_f32_16x16x32_bf16 v[24:27], a[112:115], a[16:19], v[24:27]
    s_mov_b32 m0, s56
    v_exp_f32 v31, v31
    v_mfma_f32_16x16x32_bf16 v[24:27], a[116:119], a[20:23], v[24:27]
    ds_read_b128 a[236:239], v5 offset:11264
    v_cvt_pk_bf16_f32 v49, v30, v31
    v_smfmac_f32_16x16x64_bf16 v[168:171], a[244:247], v[60:67], v255
    s_waitcnt lgkmcnt(2)
    v_cmp_ne_u32 s[64:65], s69, v18
    v_cmp_lt_u32 s[66:67], s55, v242
    s_cmp_lg_u64 s[66:67], 0
    s_cbranch_scc1 L_lw13
L_lwr13:
    v_mfma_f32_16x16x32_bf16 v[156:159], a[156:159], v[60:63], v[156:159]
    s_wqm_b64 s[64:65], s[64:65]
    v_exp_f32 v32, v32
    v_mfma_f32_16x16x32_bf16 v[156:159], a[180:183], v[64:67], v[156:159]
    s_lshr_b64 s[66:67], s[64:65], 4
    v_exp_f32 v33, v33
    v_mfma_f32_16x16x32_bf16 v[160:163], a[160:163], v[60:63], v[160:163]
    s_or_b64 s[64:65], s[64:65], s[66:67]
    ds_read_b128 a[48:51], v2 offset:0
    v_cvt_pk_bf16_f32 v50, v32, v33
    v_mfma_f32_16x16x32_bf16 v[160:163], a[184:187], v[64:67], v[160:163]
    s_and_b64 s[60:61], s[60:61], s[64:65]
    v_exp_f32 v34, v34
    v_mfma_f32_16x16x32_bf16 v[164:167], a[164:167], v[60:63], v[164:167]
    s_andn2_b64 s[64:65], s[62:63], s[60:61]
    v_exp_f32 v35, v35
    v_mfma_f32_16x16x32_bf16 v[164:167], a[188:191], v[64:67], v[164:167]
    s_or_b64 s[64:65], s[64:65], vcc
    ds_read_b128 a[52:55], v2 offset:1024
    v_cvt_pk_bf16_f32 v51, v34, v35
    v_mfma_f32_16x16x32_bf16 v[28:31], a[120:123], a[12:15], v[76:79]
    s_waitcnt lgkmcnt(2)
    v_exp_f32 v20, v20
    v_mfma_f32_16x16x32_bf16 v[28:31], a[124:127], a[16:19], v[28:31]
    s_cbranch_scc0 L_slow13
L_pick13:
    v_exp_f32 v21, v21
    v_mfma_f32_16x16x32_bf16 v[28:31], a[128:131], a[20:23], v[28:31]
    s_ff1_i32_b64 s58, s[64:65]
    ds_read_b128 a[56:59], v2 offset:2048
    v_cvt_pk_bf16_f32 v52, v20, v21
    v_mfma_f32_16x16x32_bf16 v[32:35], a[132:135], a[12:15], v[76:79]
    s_bitset0_b64 s[62:63], s58
    v_exp_f32 v22, v22
    v_mfma_f32_16x16x32_bf16 v[32:35], a[136:139], a[16:19], v[32:35]
    s_mul_i32 s57, s58, 6144
    v_exp_f32 v23, v23
    v_mfma_f32_16x16x32_bf16 v[32:35], a[140:143], a[20:23], v[32:35]
    s_add_u32 s57, s57, s49
    ds_read_b128 a[60:63], v2 offset:3072
    v_cvt_pk_bf16_f32 v53, v22, v23
    v_mfma_f32_16x16x32_bf16 v[88:91], a[192:195], v[44:47], v[88:91]
    s_add_u32 s38, s16, s57
    v_exp_f32 v24, v24
    v_mfma_f32_16x16x32_bf16 v[88:91], a[216:219], v[48:51], v[88:91]
    s_addc_u32 s39, s17, 0
    v_exp_f32 v25, v25
    v_mfma_f32_16x16x32_bf16 v[92:95], a[196:199], v[44:47], v[92:95]
    ds_read_b128 a[64:67], v2 offset:4096
    v_cvt_pk_bf16_f32 v54, v24, v25
    v_mfma_f32_16x16x32_bf16 v[92:95], a[220:223], v[48:51], v[92:95]
    v_exp_f32 v26, v26
    v_mfma_f32_16x16x32_bf16 v[96:99], a[200:203], v[44:47], v[96:99]
    v_exp_f32 v27, v27
    v_mfma_f32_16x16x32_bf16 v[96:99], a[224:227], v[48:51], v[96:99]
    ds_read_b128 a[68:71], v2 offset:5120
    v_cvt_pk_bf16_f32 v55, v26, v27
    v_mfma_f32_16x16x32_bf16 v[20:23], a[96:99], a[24:27], v[80:83]
    v_exp_f32 v28, v28
    v_mfma_f32_16x16x32_bf16 v[20:23], a[100:103], a[28:31], v[20:23]
    v_exp_f32 v29, v29
    v_mfma_f32_16x16x32_bf16 v[20:23], a[104:107], a[32:35], v[20:23]
    ds_read_b128 a[72:75], v3 offset:0
    v_cvt_pk_bf16_f32 v56, v28, v29
    v_mfma_f32_16x16x32_bf16 v[24:27], a[108:111], a[24:27], v[80:83]
    v_exp_f32 v30, v30
    v_mfma_f32_16x16x32_bf16 v[24:27], a[112:115], a[28:31], v[24:27]
    v_exp_f32 v31, v31
    v_mfma_f32_16x16x32_bf16 v[24:27], a[116:119], a[32:35], v[24:27]
    ds_read_b128 a[76:79], v3 offset:1024
    v_cvt_pk_bf16_f32 v57, v30, v31
    v_mfma_f32_16x16x32_bf16 v[100:103], a[204:207], v[44:47], v[100:103]
    v_exp_f32 v32, v32
    v_mfma_f32_16x16x32_bf16 v[100:103], a[228:231], v[48:51], v[100:103]
    v_exp_f32 v33, v33
    v_mfma_f32_16x16x32_bf16 v[104:107], a[208:211], v[44:47], v[104:107]
    ds_read_b128 a[80:83], v3 offset:2048
    v_cvt_pk_bf16_f32 v58, v32, v33
    v_mfma_f32_16x16x32_bf16 v[104:107], a[232:235], v[48:51], v[104:107]
    v_exp_f32 v34, v34
    v_mfma_f32_16x16x32_bf16 v[108:111], a[212:215], v[44:47], v[108:111]
    s_sub_u32 s55, s55, 1
    v_exp_f32 v35, v35
    v_mfma_f32_16x16x32_bf16 v[108:111], a[236:239], v[48:51], v[108:111]
    ds_read_b128 a[84:87], v3 offset:3072
    v_cvt_pk_bf16_f32 v59, v34, v35
    v_smfmac_f32_16x16x64_bf16 v[112:115], a[244:247], v[44:51], v255
    s_cbranch_vccnz L_sk13_0
    global_load_lds_dwordx4 v10, s[38:39] offset:0 sc1
    global_load_lds_dwordx4 v10, s[38:39] offset:1024 sc1
L_sk13_0:
    s_cbranch_scc0 L_back13
    v_mfma_f32_16x16x32_bf16 v[28:31], a[120:123], a[24:27], v[80:83]
    s_mul_i32 s51, s48, 7168
    v_exp_f32 v20, v20
    v_mfma_f32_16x16x32_bf16 v[28:31], a[124:127], a[28:31], v[28:31]
    s_add_u32 s51, s51, 98304
    v_exp_f32 v21, v21
    v_mfma_f32_16x16x32_bf16 v[28:31], a[128:131], a[32:35], v[28:31]
    v_add_u32 v200, s51, v1
    v_cvt_pk_bf16_f32 v60, v20, v21
    v_mfma_f32_16x16x32_bf16 v[32:35], a[132:135], a[24:27], v[80:83]
    s_mov_b32 s50, 310378496
    v_exp_f32 v22, v22
    v_mfma_f32_16x16x32_bf16 v[32:35], a[136:139], a[28:31], v[32:35]
    s_mov_b32 s18, 1258291200
    v_exp_f32 v23, v23
    v_mfma_f32_16x16x32_bf16 v[32:35], a[140:143], a[32:35], v[32:35]
    ds_write_b128 v200, v[172:175] offset:0
    v_cvt_pk_bf16_f32 v61, v22, v23
    v_add_f32 v112, v112, v113
    v_mfma_f32_16x16x32_bf16 v[116:119], a[192:195], v[52:55], v[116:119]
    v_exp_f32 v24, v24
    v_rcp_f32 v36, v112
    v_mfma_f32_16x16x32_bf16 v[116:119], a[216:219], v[56:59], v[116:119]
    v_exp_f32 v25, v25
    v_mul_f32 v88, v88, v36
    v_mul_f32 v89, v89, v36
    v_mfma_f32_16x16x32_bf16 v[120:123], a[196:199], v[52:55], v[120:123]
    ds_write_b128 v200, v[176:179] offset:1024
    v_cvt_pk_bf16_f32 v62, v24, v25
    v_mul_f32 v90, v90, v36
    v_mul_f32 v91, v91, v36
    v_mfma_f32_16x16x32_bf16 v[120:123], a[220:223], v[56:59], v[120:123]
    v_exp_f32 v26, v26
    v_mul_f32 v92, v92, v36
    v_mul_f32 v93, v93, v36
    v_mfma_f32_16x16x32_bf16 v[124:127], a[200:203], v[52:55], v[124:127]
    v_exp_f32 v27, v27
    v_mul_f32 v94, v94, v36
    v_mul_f32 v95, v95, v36
    v_mfma_f32_16x16x32_bf16 v[124:127], a[224:227], v[56:59], v[124:127]
    ds_write_b128 v200, v[180:183] offset:2048
    v_cvt_pk_bf16_f32 v63, v26, v27
    v_cvt_pk_bf16_f32 v88, v88, v89
    v_cvt_pk_bf16_f32 v89, v90, v91
    v_smfmac_f32_16x16x64_bf16 v[140:143], a[244:247], v[52:59], v255
    v_exp_f32 v28, v28
    v_cvt_pk_bf16_f32 v90, v92, v93
    v_cvt_pk_bf16_f32 v91, v94, v95
    buffer_store_dwordx4 v[88:91], v13, s[28:31], 0 offen offset:0 sc0 sc1
    v_mfma_f32_16x16x32_bf16 v[128:131], a[204:207], v[52:55], v[128:131]
    v_exp_f32 v29, v29
    v_mul_f32 v96, v96, v36
    v_mul_f32 v97, v97, v36
    v_mfma_f32_16x16x32_bf16 v[128:131], a[228:231], v[56:59], v[128:131]
    ds_write_b128 v200, v[184:187] offset:3072
    v_cvt_pk_bf16_f32 v64, v28, v29
    v_mul_f32 v98, v98, v36
    v_mul_f32 v99, v99, v36
    v_mfma_f32_16x16x32_bf16 v[132:135], a[208:211], v[52:55], v[132:135]
    v_exp_f32 v30, v30
    v_mul_f32 v100, v100, v36
    v_mul_f32 v101, v101, v36
    v_mfma_f32_16x16x32_bf16 v[132:135], a[232:235], v[56:59], v[132:135]
    v_exp_f32 v31, v31
    v_mul_f32 v102, v102, v36
    v_mul_f32 v103, v103, v36
    v_mfma_f32_16x16x32_bf16 v[136:139], a[212:215], v[52:55], v[136:139]
    ds_write_b128 v200, v[188:191] offset:4096
    v_cvt_pk_bf16_f32 v65, v30, v31
    v_cvt_pk_bf16_f32 v96, v96, v97
    v_cvt_pk_bf16_f32 v97, v98, v99
    v_mfma_f32_16x16x32_bf16 v[136:139], a[236:239], v[56:59], v[136:139]
    v_exp_f32 v32, v32
    v_cvt_pk_bf16_f32 v98, v100, v101
    v_cvt_pk_bf16_f32 v99, v102, v103
    buffer_store_dwordx4 v[96:99], v13, s[28:31], 0 offen offset:64 sc0 sc1
    v_exp_f32 v33, v33
    ds_write_b128 v200, v[192:195] offset:5120
    v_cvt_pk_bf16_f32 v66, v32, v33
    v_exp_f32 v34, v34
    v_exp_f32 v35, v35
    v_add_f32 v140, v140, v141
    v_cvt_pk_bf16_f32 v67, v34, v35
    v_rcp_f32 v38, v140
    s_nop 0
    v_smfmac_f32_16x16x64_bf16 v[168:171], a[244:247], v[60:67], v255
    v_mfma_f32_16x16x32_bf16 v[144:147], a[192:195], v[60:63], v[144:147]
    v_mul_f32 v104, v104, v36
    v_mul_f32 v105, v105, v36
    v_mfma_f32_16x16x32_bf16 v[144:147], a[216:219], v[64:67], v[144:147]
    v_mul_f32 v106, v106, v36
    v_mul_f32 v107, v107, v36
    v_mfma_f32_16x16x32_bf16 v[148:151], a[196:199], v[60:63], v[148:151]
    v_mul_f32 v108, v108, v36
    v_mul_f32 v109, v109, v36
    v_mfma_f32_16x16x32_bf16 v[148:151], a[220:223], v[64:67], v[148:151]
    v_mul_f32 v110, v110, v36
    v_mul_f32 v111, v111, v36
    v_mfma_f32_16x16x32_bf16 v[152:155], a[200:203], v[60:63], v[152:155]
    v_cvt_pk_bf16_f32 v104, v104, v105
    v_cvt_pk_bf16_f32 v105, v106, v107
    v_mfma_f32_16x16x32_bf16 v[152:155], a[224:227], v[64:67], v[152:155]
    v_cvt_pk_bf16_f32 v106, v108, v109
    v_cvt_pk_bf16_f32 v107, v110, v111
    v_mfma_f32_16x16x32_bf16 v[156:159], a[204:207], v[60:63], v[156:159]
    buffer_store_dwordx4 v[104:107], v13, s[28:31], 0 offen offset:128 sc0 sc1
    v_mul_f32 v116, v116, v38
    v_mfma_f32_16x16x32_bf16 v[156:159], a[228:231], v[64:67], v[156:159]
    v_mul_f32 v117, v117, v38
    v_mul_f32 v118, v118, v38
    v_mfma_f32_16x16x32_bf16 v[160:163], a[208:211], v[60:63], v[160:163]
    v_mul_f32 v119, v119, v38
    v_mul_f32 v120, v120, v38
    v_mfma_f32_16x16x32_bf16 v[160:163], a[232:235], v[64:67], v[160:163]
    v_mul_f32 v121, v121, v38
    v_mul_f32 v122, v122, v38
    v_mfma_f32_16x16x32_bf16 v[164:167], a[212:215], v[60:63], v[164:167]
    v_mul_f32 v123, v123, v38
    v_cvt_pk_bf16_f32 v116, v116, v117
    v_mfma_f32_16x16x32_bf16 v[164:167], a[236:239], v[64:67], v[164:167]
    v_cvt_pk_bf16_f32 v117, v118, v119
    v_cvt_pk_bf16_f32 v118, v120, v121
    v_cvt_pk_bf16_f32 v119, v122, v123
    buffer_store_dwordx4 v[116:119], v14, s[28:31], 0 offen offset:0 sc0 sc1
    v_add_f32 v168, v168, v169
    v_subrev_u32 v37, s50, v112
    v_cmp_le_u32 s[64:65], s18, v37
    v_subrev_u32 v39, s50, v140
    v_cmp_le_u32 s[66:67], s18, v39
    v_subrev_u32 v41, s50, v168
    v_cmp_le_u32 vcc, s18, v41
    v_rcp_f32 v40, v168
    s_or_b64 s[64:65], s[64:65], s[66:67]
    s_or_b64 s[64:65], s[64:65], vcc
    s_cselect_b32 s51, 1, 0
    v_mov_b32 v197, s51
    ds_write_b64 v200, v[196:197] offset:6144
    v_add_u32 v18, 98304, v1
    s_lshl_b32 s51, s48, 11
    s_add_u32 s51, s51, 98304
    v_add_u32 v19, s51, v1
    v_pk_mul_f32 v[124:125], v[124:125], v[38:39] op_sel_hi:[1,0]
    v_pk_mul_f32 v[126:127], v[126:127], v[38:39] op_sel_hi:[1,0]
    v_pk_mul_f32 v[128:129], v[128:129], v[38:39] op_sel_hi:[1,0]
    v_pk_mul_f32 v[130:131], v[130:131], v[38:39] op_sel_hi:[1,0]
    v_cvt_pk_bf16_f32 v124, v124, v125
    v_cvt_pk_bf16_f32 v125, v126, v127
    v_cvt_pk_bf16_f32 v126, v128, v129
    v_cvt_pk_bf16_f32 v127, v130, v131
    buffer_store_dwordx4 v[124:127], v14, s[28:31], 0 offen offset:64 sc0 sc1
    s_waitcnt lgkmcnt(0)
    s_barrier
    ds_read_b64 v[20:21], v18 offset:6144
    ds_read_b64 v[22:23], v18 offset:13312
    ds_read_b64 v[24:25], v18 offset:20480
    ds_read_b64 v[26:27], v18 offset:27648
    ds_read_b128 v[200:203], v19 offset:0
    ds_read_b128 v[204:207], v19 offset:1024
    ds_read_b128 v[208:211], v19 offset:7168
    ds_read_b128 v[212:215], v19 offset:8192
    ds_read_b128 v[216:219], v19 offset:14336
    ds_read_b128 v[220:223], v19 offset:15360
    ds_read_b128 v[224:227], v19 offset:21504
    ds_read_b128 v[228:231], v19 offset:22528
    v_pk_mul_f32 v[132:133], v[132:133], v[38:39] op_sel_hi:[1,0]
    v_pk_mul_f32 v[134:135], v[134:135], v[38:39] op_sel_hi:[1,0]
    v_pk_mul_f32 v[136:137], v[136:137], v[38:39] op_sel_hi:[1,0]
    v_pk_mul_f32 v[138:139], v[138:139], v[38:39] op_sel_hi:[1,0]
    v_cvt_pk_bf16_f32 v132, v132, v133
    v_cvt_pk_bf16_f32 v133, v134, v135
    v_cvt_pk_bf16_f32 v134, v136, v137
    v_cvt_pk_bf16_f32 v135, v138, v139
    buffer_store_dwordx4 v[132:135], v14, s[28:31], 0 offen offset:128 sc0 sc1
    v_pk_mul_f32 v[144:145], v[144:145], v[40:41] op_sel_hi:[1,0]
    v_pk_mul_f32 v[146:147], v[146:147], v[40:41] op_sel_hi:[1,0]
    v_pk_mul_f32 v[148:149], v[148:149], v[40:41] op_sel_hi:[1,0]
    v_pk_mul_f32 v[150:151], v[150:151], v[40:41] op_sel_hi:[1,0]
    v_cvt_pk_bf16_f32 v144, v144, v145
    v_cvt_pk_bf16_f32 v145, v146, v147
    v_cvt_pk_bf16_f32 v146, v148, v149
    v_cvt_pk_bf16_f32 v147, v150, v151
    buffer_store_dwordx4 v[144:147], v15, s[28:31], 0 offen offset:0 sc0 sc1
    v_pk_mul_f32 v[152:153], v[152:153], v[40:41] op_sel_hi:[1,0]
    v_pk_mul_f32 v[154:155], v[154:155], v[40:41] op_sel_hi:[1,0]
    v_pk_mul_f32 v[156:157], v[156:157], v[40:41] op_sel_hi:[1,0]
    v_pk_mul_f32 v[158:159], v[158:159], v[40:41] op_sel_hi:[1,0]
    v_cvt_pk_bf16_f32 v152, v152, v153
    v_cvt_pk_bf16_f32 v153, v154, v155
    v_cvt_pk_bf16_f32 v154, v156, v157
    v_cvt_pk_bf16_f32 v155, v158, v159
    buffer_store_dwordx4 v[152:155], v15, s[28:31], 0 offen offset:64 sc0 sc1
    v_pk_mul_f32 v[160:161], v[160:161], v[40:41] op_sel_hi:[1,0]
    v_pk_mul_f32 v[162:163], v[162:163], v[40:41] op_sel_hi:[1,0]
    v_pk_mul_f32 v[164:165], v[164:165], v[40:41] op_sel_hi:[1,0]
    v_pk_mul_f32 v[166:167], v[166:167], v[40:41] op_sel_hi:[1,0]
    v_cvt_pk_bf16_f32 v160, v160, v161
    v_cvt_pk_bf16_f32 v161, v162, v163
    v_cvt_pk_bf16_f32 v162, v164, v165
    v_cvt_pk_bf16_f32 v163, v166, v167
    buffer_store_dwordx4 v[160:163], v15, s[28:31], 0 offen offset:128 sc0 sc1
    s_waitcnt lgkmcnt(0)
    v_add_f32 v20, v20, v22
    v_add_f32 v24, v24, v26
    v_or_b32 v21, v21, v23
    v_or3_b32 v21, v21, v25, v27
    v_add_f32 v20, v20, v24
    v_cmp_ne_u32 s[64:65], 0, v21
    v_subrev_u32 v39, s50, v20
    v_cmp_le_u32 s[66:67], s18, v39
    v_rcp_f32 v36, v20
    s_cmp_eq_u32 s48, 3
    s_cbranch_scc1 L_notstore
    v_pk_add_f32 v[200:201], v[200:201], v[208:209]
    v_pk_add_f32 v[216:217], v[216:217], v[224:225]
    v_pk_add_f32 v[202:203], v[202:203], v[210:211]
    v_pk_add_f32 v[218:219], v[218:219], v[226:227]
    v_pk_add_f32 v[204:205], v[204:205], v[212:213]
    v_pk_add_f32 v[220:221], v[220:221], v[228:229]
    v_pk_add_f32 v[206:207], v[206:207], v[214:215]
    v_pk_add_f32 v[222:223], v[222:223], v[230:231]
    v_pk_add_f32 v[200:201], v[200:201], v[216:217]
    v_pk_add_f32 v[202:203], v[202:203], v[218:219]
    v_pk_add_f32 v[204:205], v[204:205], v[220:221]
    v_pk_add_f32 v[206:207], v[206:207], v[222:223]
    v_pk_mul_f32 v[200:201], v[200:201], v[36:37] op_sel_hi:[1,0]
    v_pk_mul_f32 v[202:203], v[202:203], v[36:37] op_sel_hi:[1,0]
    v_pk_mul_f32 v[204:205], v[204:205], v[36:37] op_sel_hi:[1,0]
    v_pk_mul_f32 v[206:207], v[206:207], v[36:37] op_sel_hi:[1,0]
    v_cvt_pk_bf16_f32 v200, v200, v201
    v_cvt_pk_bf16_f32 v201, v202, v203
    v_cvt_pk_bf16_f32 v202, v204, v205
    v_cvt_pk_bf16_f32 v203, v206, v207
    s_lshl_b32 s50, s48, 6
    buffer_store_dwordx4 v[200:203], v16, s[28:31], s50 offen sc0 sc1
    s_branch L_notstore
L_touch13:
    s_setpc_b64 s[66:67]
.p2align 6
L_back12:
    v_mfma_f32_16x16x32_bf16 v[28:31], a[120:123], a[24:27], v[80:83]
    v_exp_f32 v20, v20
    v_mfma_f32_16x16x32_bf16 v[28:31], a[124:127], a[28:31], v[28:31]
    v_exp_f32 v21, v21
    v_mfma_f32_16x16x32_bf16 v[28:31], a[128:131], a[32:35], v[28:31]
    ds_read_b128 a[88:91], v3 offset:4096
    v_cvt_pk_bf16_f32 v60, v20, v21
    v_mfma_f32_16x16x32_bf16 v[32:35], a[132:135], a[24:27], v[80:83]
    v_exp_f32 v22, v22
    v_mfma_f32_16x16x32_bf16 v[32:35], a[136:139], a[28:31], v[32:35]
    v_exp_f32 v23, v23
    v_mfma_f32_16x16x32_bf16 v[32:35], a[140:143], a[32:35], v[32:35]
    ds_read_b128 a[92:95], v3 offset:5120
    v_cvt_pk_bf16_f32 v61, v22, v23
    v_mfma_f32_16x16x32_bf16 v[116:119], a[192:195], v[52:55], v[116:119]
    v_exp_f32 v24, v24
    v_mfma_f32_16x16x32_bf16 v[116:119], a[216:219], v[56:59], v[116:119]
    v_exp_f32 v25, v25
    v_mfma_f32_16x16x32_bf16 v[120:123], a[196:199], v[52:55], v[120:123]
    ds_read_b128 a[144:147], v2 offset:6144
    v_cvt_pk_bf16_f32 v62, v24, v25
    v_mfma_f32_16x16x32_bf16 v[120:123], a[220:223], v[56:59], v[120:123]
    v_exp_f32 v26, v26
    v_mfma_f32_16x16x32_bf16 v[124:127], a[200:203], v[52:55], v[124:127]
    v_exp_f32 v27, v27
    v_mfma_f32_16x16x32_bf16 v[124:127], a[224:227], v[56:59], v[124:127]
    s_waitcnt lgkmcnt(1)
    ds_read_b128 a[148:151], v2 offset:7168
    v_cvt_pk_bf16_f32 v63, v26, v27
    v_mfma_f32_16x16x32_bf16 v[20:23], a[48:51], a[0:3], v[72:75]
    s_mov_b32 s54, s52
    v_exp_f32 v28, v28
    v_mfma_f32_16x16x32_bf16 v[20:23], a[52:55], a[4:7], v[20:23]
    s_add_u32 s59, s53, 49152
    v_exp_f32 v29, v29
    v_mfma_f32_16x16x32_bf16 v[20:23], a[56:59], a[8:11], v[20:23]
    ds_read_b128 a[152:155], v2 offset:8192
    v_cvt_pk_bf16_f32 v64, v28, v29
    v_mfma_f32_16x16x32_bf16 v[24:27], a[60:63], a[0:3], v[72:75]
    s_cmp_eq_u32 s59, 147456
    v_exp_f32 v30, v30
    v_mfma_f32_16x16x32_bf16 v[24:27], a[64:67], a[4:7], v[24:27]
    s_mov_b32 s52, s53
    v_exp_f32 v31, v31
    v_mfma_f32_16x16x32_bf16 v[24:27], a[68:71], a[8:11], v[24:27]
    ds_read_b128 a[156:159], v2 offset:9216
    v_cvt_pk_bf16_f32 v65, v30, v31
    v_mfma_f32_16x16x32_bf16 v[128:131], a[204:207], v[52:55], v[128:131]
    s_cselect_b32 s53, 0, s59
    v_exp_f32 v32, v32
    v_mfma_f32_16x16x32_bf16 v[128:131], a[228:231], v[56:59], v[128:131]
    v_exp_f32 v33, v33
    v_mfma_f32_16x16x32_bf16 v[132:135], a[208:211], v[52:55], v[132:135]
    ds_read_b128 a[160:163], v2 offset:10240
    v_cvt_pk_bf16_f32 v66, v32, v33
    v_mfma_f32_16x16x32_bf16 v[132:135], a[232:235], v[56:59], v[132:135]
    v_exp_f32 v34, v34
    v_mfma_f32_16x16x32_bf16 v[136:139], a[212:215], v[52:55], v[136:139]
    v_exp_f32 v35, v35
    v_mfma_f32_16x16x32_bf16 v[136:139], a[236:239], v[56:59], v[136:139]
    s_add_u32 m0, s56, 4096
    ds_read_b128 a[164:167], v2 offset:11264
    v_cvt_pk_bf16_f32 v67, v34, v35
    v_smfmac_f32_16x16x64_bf16 v[140:143], a[244:247], v[52:59], v255
    s_cbranch_vccnz L_sk12_1
    global_load_lds_dwordx4 v11, s[38:39] offset:0 sc1
    global_load_lds_dwordx4 v11, s[38:39] offset:1024 sc1
    global_load_lds_dwordx4 v11, s[38:39] offset:2048 sc1
    global_load_lds_dwordx4 v11, s[38:39] offset:3072 sc1
L_sk12_1:
L_loop12:
    v_mfma_f32_16x16x32_bf16 v[28:31], a[72:75], a[0:3], v[72:75]
    v_exp_f32 v20, v20
    v_mfma_f32_16x16x32_bf16 v[28:31], a[76:79], a[4:7], v[28:31]
    v_exp_f32 v21, v21
    v_mfma_f32_16x16x32_bf16 v[28:31], a[80:83], a[8:11], v[28:31]
    ds_read_b128 a[168:171], v3 offset:6144
    v_cvt_pk_bf16_f32 v44, v20, v21
    v_mfma_f32_16x16x32_bf16 v[32:35], a[84:87], a[0:3], v[72:75]
    v_exp_f32 v22, v22
    v_mfma_f32_16x16x32_bf16 v[32:35], a[88:91], a[4:7], v[32:35]
    v_exp_f32 v23, v23
    v_mfma_f32_16x16x32_bf16 v[32:35], a[92:95], a[8:11], v[32:35]
    ds_read_b128 a[172:175], v3 offset:7168
    v_cvt_pk_bf16_f32 v45, v22, v23
    v_mfma_f32_16x16x32_bf16 v[144:147], a[192:195], v[60:63], v[144:147]
    v_exp_f32 v24, v24
    v_mfma_f32_16x16x32_bf16 v[144:147], a[216:219], v[64:67], v[144:147]
    v_exp_f32 v25, v25
    v_mfma_f32_16x16x32_bf16 v[148:151], a[196:199], v[60:63], v[148:151]
    ds_read_b128 a[176:179], v3 offset:8192
    v_cvt_pk_bf16_f32 v46, v24, v25
    v_mfma_f32_16x16x32_bf16 v[148:151], a[220:223], v[64:67], v[148:151]
    v_exp_f32 v26, v26
    v_mfma_f32_16x16x32_bf16 v[152:155], a[200:203], v[60:63], v[152:155]
    v_exp_f32 v27, v27
    v_mfma_f32_16x16x32_bf16 v[152:155], a[224:227], v[64:67], v[152:155]
    ds_read_b128 a[180:183], v3 offset:9216
    v_cvt_pk_bf16_f32 v47, v26, v27
    v_mfma_f32_16x16x32_bf16 v[20:23], a[48:51], a[12:15], v[76:79]
    v_exp_f32 v28, v28
    v_mfma_f32_16x16x32_bf16 v[20:23], a[52:55], a[16:19], v[20:23]
    v_exp_f32 v29, v29
    v_mfma_f32_16x16x32_bf16 v[20:23], a[56:59], a[20:23], v[20:23]
    ds_read_b128 a[184:187], v3 offset:10240
    v_cvt_pk_bf16_f32 v48, v28, v29
    v_mfma_f32_16x16x32_bf16 v[24:27], a[60:63], a[12:15], v[76:79]
    v_exp_f32 v30, v30
    v_mfma_f32_16x16x32_bf16 v[24:27], a[64:67], a[16:19], v[24:27]
    v_exp_f32 v31, v31
    v_mfma_f32_16x16x32_bf16 v[24:27], a[68:71], a[20:23], v[24:27]
    ds_read_b128 a[188:191], v3 offset:11264
    v_cvt_pk_bf16_f32 v49, v30, v31
    v_mfma_f32_16x16x32_bf16 v[156:159], a[204:207], v[60:63], v[156:159]
    v_exp_f32 v32, v32
    v_mfma_f32_16x16x32_bf16 v[156:159], a[228:231], v[64:67], v[156:159]
    v_exp_f32 v33, v33
    v_mfma_f32_16x16x32_bf16 v[160:163], a[208:211], v[60:63], v[160:163]
    ds_read_b128 a[96:99], v4 offset:0
    v_cvt_pk_bf16_f32 v50, v32, v33
    v_mfma_f32_16x16x32_bf16 v[160:163], a[232:235], v[64:67], v[160:163]
    v_exp_f32 v34, v34
    v_mfma_f32_16x16x32_bf16 v[164:167], a[212:215], v[60:63], v[164:167]
    v_exp_f32 v35, v35
    v_mfma_f32_16x16x32_bf16 v[164:167], a[236:239], v[64:67], v[164:167]
    s_add_u32 m0, s56, 8192
    ds_read_b128 a[100:103], v4 offset:1024
    v_cvt_pk_bf16_f32 v51, v34, v35
    v_smfmac_f32_16x16x64_bf16 v[168:171], a[244:247], v[60:67], v255
    s_cbranch_vccnz L_sk12_2
    global_load_lds_dwordx4 v12, s[38:39] offset:0 sc1
    global_load_lds_dwordx4 v12, s[38:39] offset:1024 sc1
    global_load_lds_dwordx4 v12, s[38:39] offset:2048 sc1
    global_load_lds_dwordx4 v12, s[38:39] offset:3072 sc1
L_sk12_2:
    buffer_load_dword v18, v17, s[20:23], 0 offen sc1
    v_mfma_f32_16x16x32_bf16 v[28:31], a[72:75], a[12:15], v[76:79]
    s_waitcnt lgkmcnt(2)
    v_exp_f32 v20, v20
    v_mfma_f32_16x16x32_bf16 v[28:31], a[76:79], a[16:19], v[28:31]
    v_exp_f32 v21, v21
    v_mfma_f32_16x16x32_bf16 v[28:31], a[80:83], a[20:23], v[28:31]
    ds_read_b128 a[104:107], v4 offset:2048
    v_cvt_pk_bf16_f32 v52, v20, v21
    v_mfma_f32_16x16x32_bf16 v[32:35], a[84:87], a[12:15], v[76:79]
    v_exp_f32 v22, v22
    v_mfma_f32_16x16x32_bf16 v[32:35], a[88:91], a[16:19], v[32:35]
    v_exp_f32 v23, v23
    v_mfma_f32_16x16x32_bf16 v[32:35], a[92:95], a[20:23], v[32:35]
    ds_read_b128 a[108:111], v4 offset:3072
    v_cvt_pk_bf16_f32 v53, v22, v23
    v_mfma_f32_16x16x32_bf16 v[88:91], a[144:147], v[44:47], v[88:91]
    v_exp_f32 v24, v24
    v_mfma_f32_16x16x32_bf16 v[88:91], a[168:171], v[48:51], v[88:91]
    v_exp_f32 v25, v25
    v_mfma_f32_16x16x32_bf16 v[92:95], a[148:151], v[44:47], v[92:95]
    ds_read_b128 a[112:115], v4 offset:4096
    v_cvt_pk_bf16_f32 v54, v24, v25
    v_mfma_f32_16x16x32_bf16 v[92:95], a[172:175], v[48:51], v[92:95]
    v_exp_f32 v26, v26
    v_mfma_f32_16x16x32_bf16 v[96:99], a[152:155], v[44:47], v[96:99]
    v_exp_f32 v27, v27
    v_mfma_f32_16x16x32_bf16 v[96:99], a[176:179], v[48:51], v[96:99]
    ds_read_b128 a[116:119], v4 offset:5120
    v_cvt_pk_bf16_f32 v55, v26, v27
    v_mfma_f32_16x16x32_bf16 v[20:23], a[48:51], a[24:27], v[80:83]
    v_exp_f32 v28, v28
    v_mfma_f32_16x16x32_bf16 v[20:23], a[52:55], a[28:31], v[20:23]
    v_exp_f32 v29, v29
    v_mfma_f32_16x16x32_bf16 v[20:23], a[56:59], a[32:35], v[20:23]
    ds_read_b128 a[120:123], v5 offset:0
    v_cvt_pk_bf16_f32 v56, v28, v29
    v_mfma_f32_16x16x32_bf16 v[24:27], a[60:63], a[24:27], v[80:83]
    v_exp_f32 v30, v30
    v_mfma_f32_16x16x32_bf16 v[24:27], a[64:67], a[28:31], v[24:27]
    v_exp_f32 v31, v31
    v_mfma_f32_16x16x32_bf16 v[24:27], a[68:71], a[32:35], v[24:27]
    ds_read_b128 a[124:127], v5 offset:1024
    v_cvt_pk_bf16_f32 v57, v30, v31
    v_mfma_f32_16x16x32_bf16 v[100:103], a[156:159], v[44:47], v[100:103]
    v_exp_f32 v32, v32
    v_mfma_f32_16x16x32_bf16 v[100:103], a[180:183], v[48:51], v[100:103]
    v_exp_f32 v33, v33
    v_mfma_f32_16x16x32_bf16 v[104:107], a[160:163], v[44:47], v[104:107]
    ds_read_b128 a[128:131], v5 offset:2048
    v_cvt_pk_bf16_f32 v58, v32, v33
    v_mfma_f32_16x16x32_bf16 v[104:107], a[184:187], v[48:51], v[104:107]
    v_exp_f32 v34, v34
    v_mfma_f32_16x16x32_bf16 v[108:111], a[164:167], v[44:47], v[108:111]
    v_exp_f32 v35, v35
    v_mfma_f32_16x16x32_bf16 v[108:111], a[188:191], v[48:51], v[108:111]
    ds_read_b128 a[132:135], v5 offset:3072
    v_cvt_pk_bf16_f32 v59, v34, v35
    v_smfmac_f32_16x16x64_bf16 v[112:115], a[244:247], v[44:51], v255
    v_mfma_f32_16x16x32_bf16 v[28:31], a[72:75], a[24:27], v[80:83]
    v_exp_f32 v20, v20
    v_mfma_f32_16x16x32_bf16 v[28:31], a[76:79], a[28:31], v[28:31]
    v_exp_f32 v21, v21
    v_mfma_f32_16x16x32_bf16 v[28:31], a[80:83], a[32:35], v[28:31]
    ds_read_b128 a[136:139], v5 offset:4096
    v_cvt_pk_bf16_f32 v60, v20, v21
    v_mfma_f32_16x16x32_bf16 v[32:35], a[84:87], a[24:27], v[80:83]
    v_exp_f32 v22, v22
    v_mfma_f32_16x16x32_bf16 v[32:35], a[88:91], a[28:31], v[32:35]
    v_exp_f32 v23, v23
    v_mfma_f32_16x16x32_bf16 v[32:35], a[92:95], a[32:35], v[32:35]
    ds_read_b128 a[140:143], v5 offset:5120
    v_cvt_pk_bf16_f32 v61, v22, v23
    v_mfma_f32_16x16x32_bf16 v[116:119], a[144:147], v[52:55], v[116:119]
    v_exp_f32 v24, v24
    v_mfma_f32_16x16x32_bf16 v[116:119], a[168:171], v[56:59], v[116:119]
    v_exp_f32 v25, v25
    v_mfma_f32_16x16x32_bf16 v[120:123], a[148:151], v[52:55], v[120:123]
    ds_read_b128 a[192:195], v4 offset:6144
    v_cvt_pk_bf16_f32 v62, v24, v25
    v_mfma_f32_16x16x32_bf16 v[120:123], a[172:175], v[56:59], v[120:123]
    v_exp_f32 v26, v26
    v_mfma_f32_16x16x32_bf16 v[124:127], a[152:155], v[52:55], v[124:127]
    v_exp_f32 v27, v27
    v_mfma_f32_16x16x32_bf16 v[124:127], a[176:179], v[56:59], v[124:127]
    s_waitcnt lgkmcnt(1)
    ds_read_b128 a[196:199], v4 offset:7168
    v_cvt_pk_bf16_f32 v63, v26, v27
    v_mfma_f32_16x16x32_bf16 v[20:23], a[96:99], a[0:3], v[72:75]
    v_exp_f32 v28, v28
    v_mfma_f32_16x16x32_bf16 v[20:23], a[100:103], a[4:7], v[20:23]
    v_exp_f32 v29, v29
    v_mfma_f32_16x16x32_bf16 v[20:23], a[104:107], a[8:11], v[20:23]
    ds_read_b128 a[200:203], v4 offset:8192
    v_cvt_pk_bf16_f32 v64, v28, v29
    v_mfma_f32_16x16x32_bf16 v[24:27], a[108:111], a[0:3], v[72:75]
    v_exp_f32 v30, v30
    v_mfma_f32_16x16x32_bf16 v[24:27], a[112:115], a[4:7], v[24:27]
    v_exp_f32 v31, v31
    v_mfma_f32_16x16x32_bf16 v[24:27], a[116:119], a[8:11], v[24:27]
    ds_read_b128 a[204:207], v4 offset:9216
    v_cvt_pk_bf16_f32 v65, v30, v31
    v_mfma_f32_16x16x32_bf16 v[128:131], a[156:159], v[52:55], v[128:131]
    v_exp_f32 v32, v32
    v_mfma_f32_16x16x32_bf16 v[128:131], a[180:183], v[56:59], v[128:131]
    v_exp_f32 v33, v33
    v_mfma_f32_16x16x32_bf16 v[132:135], a[160:163], v[52:55], v[132:135]
    ds_read_b128 a[208:211], v4 offset:10240
    v_cvt_pk_bf16_f32 v66, v32, v33
    v_mfma_f32_16x16x32_bf16 v[132:135], a[184:187], v[56:59], v[132:135]
    v_exp_f32 v34, v34
    v_mfma_f32_16x16x32_bf16 v[136:139], a[164:167], v[52:55], v[136:139]
    v_exp_f32 v35, v35
    v_mfma_f32_16x16x32_bf16 v[136:139], a[188:191], v[56:59], v[136:139]
    ds_read_b128 a[212:215], v4 offset:11264
    v_cvt_pk_bf16_f32 v67, v34, v35
    v_smfmac_f32_16x16x64_bf16 v[140:143], a[244:247], v[52:59], v255
    v_add_u32 v2, s52, v6
    v_add_u32 v3, s52, v7
    v_mov_b32 v240, s55
    v_mfma_f32_16x16x32_bf16 v[28:31], a[120:123], a[0:3], v[72:75]
    v_exp_f32 v20, v20
    v_mfma_f32_16x16x32_bf16 v[28:31], a[124:127], a[4:7], v[28:31]
    v_exp_f32 v21, v21
    v_mfma_f32_16x16x32_bf16 v[28:31], a[128:131], a[8:11], v[28:31]
    ds_read_b128 a[216:219], v5 offset:6144
    v_cvt_pk_bf16_f32 v44, v20, v21
    v_mfma_f32_16x16x32_bf16 v[32:35], a[132:135], a[0:3], v[72:75]
    s_waitcnt vmcnt(0)
    v_exp_f32 v22, v22
    v_mfma_f32_16x16x32_bf16 v[32:35], a[136:139], a[4:7], v[32:35]
    v_exp_f32 v23, v23
    v_mfma_f32_16x16x32_bf16 v[32:35], a[140:143], a[8:11], v[32:35]
    ds_write_b32 v241, v240
    ds_read_b128 a[220:223], v5 offset:7168
    v_cvt_pk_bf16_f32 v45, v22, v23
    v_mfma_f32_16x16x32_bf16 v[144:147], a[144:147], v[60:63], v[144:147]
    v_exp_f32 v24, v24
    v_mfma_f32_16x16x32_bf16 v[144:147], a[168:171], v[64:67], v[144:147]
    v_exp_f32 v25, v25
    v_mfma_f32_16x16x32_bf16 v[148:151], a[148:151], v[60:63], v[148:151]
    ds_read_b128 a[224:227], v5 offset:8192
    v_cvt_pk_bf16_f32 v46, v24, v25
    v_mfma_f32_16x16x32_bf16 v[148:151], a[172:175], v[64:67], v[148:151]
    v_exp_f32 v26, v26
    v_mfma_f32_16x16x32_bf16 v[152:155], a[152:155], v[60:63], v[152:155]
    v_exp_f32 v27, v27
    v_mfma_f32_16x16x32_bf16 v[152:155], a[176:179], v[64:67], v[152:155]
    ds_read_b128 a[228:231], v5 offset:9216
    v_cvt_pk_bf16_f32 v47, v26, v27
    v_mfma_f32_16x16x32_bf16 v[20:23], a[96:99], a[12:15], v[76:79]
    s_cmp_lt_u32 s55, 2
    v_exp_f32 v28, v28
    v_mfma_f32_16x16x32_bf16 v[20:23], a[100:103], a[16:19], v[20:23]
    s_cselect_b64 vcc, -1, 0
    v_exp_f32 v29, v29
    v_mfma_f32_16x16x32_bf16 v[20:23], a[104:107], a[20:23], v[20:23]
    ds_read_b32 v242, v243
    ds_read_b128 a[232:235], v5 offset:10240
    v_cvt_pk_bf16_f32 v48, v28, v29
    v_mfma_f32_16x16x32_bf16 v[24:27], a[108:111], a[12:15], v[76:79]
    s_add_u32 s56, s53, s49
    v_exp_f32 v30, v30
    v_mfma_f32_16x16x32_bf16 v[24:27], a[112:115], a[16:19], v[24:27]
    s_mov_b32 m0, s56
    v_exp_f32 v31, v31
    v_mfma_f32_16x16x32_bf16 v[24:27], a[116:119], a[20:23], v[24:27]
    ds_read_b128 a[236:239], v5 offset:11264
    v_cvt_pk_bf16_f32 v49, v30, v31
    v_smfmac_f32_16x16x64_bf16 v[168:171], a[244:247], v[60:67], v255
    s_waitcnt lgkmcnt(2)
    v_cmp_ne_u32 s[64:65], s69, v18
    v_cmp_lt_u32 s[66:67], s55, v242
    s_cmp_lg_u64 s[66:67], 0
    s_cbranch_scc1 L_lw12
L_lwr12:
    v_mfma_f32_16x16x32_bf16 v[156:159], a[156:159], v[60:63], v[156:159]
    s_wqm_b64 s[64:65], s[64:65]
    v_exp_f32 v32, v32
    v_mfma_f32_16x16x32_bf16 v[156:159], a[180:183], v[64:67], v[156:159]
    s_lshr_b64 s[66:67], s[64:65], 4
    v_exp_f32 v33, v33
    v_mfma_f32_16x16x32_bf16 v[160:163], a[160:163], v[60:63], v[160:163]
    s_or_b64 s[64:65], s[64:65], s[66:67]
    ds_read_b128 a[48:51], v2 offset:0
    v_cvt_pk_bf16_f32 v50, v32, v33
    v_mfma_f32_16x16x32_bf16 v[160:163], a[184:187], v[64:67], v[160:163]
    s_and_b64 s[60:61], s[60:61], s[64:65]
    v_exp_f32 v34, v34
    v_mfma_f32_16x16x32_bf16 v[164:167], a[164:167], v[60:63], v[164:167]
    s_andn2_b64 s[64:65], s[62:63], s[60:61]
    v_exp_f32 v35, v35
    v_mfma_f32_16x16x32_bf16 v[164:167], a[188:191], v[64:67], v[164:167]
    s_or_b64 s[64:65], s[64:65], vcc
    ds_read_b128 a[52:55], v2 offset:1024
    v_cvt_pk_bf16_f32 v51, v34, v35
    v_mfma_f32_16x16x32_bf16 v[28:31], a[120:123], a[12:15], v[76:79]
    s_waitcnt lgkmcnt(2)
    v_exp_f32 v20, v20
    v_mfma_f32_16x16x32_bf16 v[28:31], a[124:127], a[16:19], v[28:31]
    s_cbranch_scc0 L_slow12
L_pick12:
    v_exp_f32 v21, v21
    v_mfma_f32_16x16x32_bf16 v[28:31], a[128:131], a[20:23], v[28:31]
    s_ff1_i32_b64 s58, s[64:65]
    ds_read_b128 a[56:59], v2 offset:2048
    v_cvt_pk_bf16_f32 v52, v20, v21
    v_mfma_f32_16x16x32_bf16 v[32:35], a[132:135], a[12:15], v[76:79]
    s_bitset0_b64 s[62:63], s58
    v_exp_f32 v22, v22
    v_mfma_f32_16x16x32_bf16 v[32:35], a[136:139], a[16:19], v[32:35]
    s_mul_i32 s57, s58, 6144
    v_exp_f32 v23, v23
    v_mfma_f32_16x16x32_bf16 v[32:35], a[140:143], a[20:23], v[32:35]
    s_add_u32 s57, s57, s49
    ds_read_b128 a[60:63], v2 offset:3072
    v_cvt_pk_bf16_f32 v53, v22, v23
    v_add_u32 v4, s52, v8
    v_mfma_f32_16x16x32_bf16 v[88:91], a[192:195], v[44:47], v[88:91]
    s_add_u32 s38, s16, s57
    v_exp_f32 v24, v24
    v_mfma_f32_16x16x32_bf16 v[88:91], a[216:219], v[48:51], v[88:91]
    s_addc_u32 s39, s17, 0
    v_exp_f32 v25, v25
    v_mfma_f32_16x16x32_bf16 v[92:95], a[196:199], v[44:47], v[92:95]
    ds_read_b128 a[64:67], v2 offset:4096
    v_cvt_pk_bf16_f32 v54, v24, v25
    v_mfma_f32_16x16x32_bf16 v[92:95], a[220:223], v[48:51], v[92:95]
    v_exp_f32 v26, v26
    v_mfma_f32_16x16x32_bf16 v[96:99], a[200:203], v[44:47], v[96:99]
    v_exp_f32 v27, v27
    v_mfma_f32_16x16x32_bf16 v[96:99], a[224:227], v[48:51], v[96:99]
    ds_read_b128 a[68:71], v2 offset:5120
    v_cvt_pk_bf16_f32 v55, v26, v27
    v_mfma_f32_16x16x32_bf16 v[20:23], a[96:99], a[24:27], v[80:83]
    v_exp_f32 v28, v28
    v_mfma_f32_16x16x32_bf16 v[20:23], a[100:103], a[28:31], v[20:23]
    v_exp_f32 v29, v29
    v_mfma_f32_16x16x32_bf16 v[20:23], a[104:107], a[32:35], v[20:23]
    ds_read_b128 a[72:75], v3 offset:0
    v_cvt_pk_bf16_f32 v56, v28, v29
    v_mfma_f32_16x16x32_bf16 v[24:27], a[108:111], a[24:27], v[80:83]
    v_exp_f32 v30, v30
    v_mfma_f32_16x16x32_bf16 v[24:27], a[112:115], a[28:31], v[24:27]
    v_exp_f32 v31, v31
    v_mfma_f32_16x16x32_bf16 v[24:27], a[116:119], a[32:35], v[24:27]
    ds_read_b128 a[76:79], v3 offset:1024
    v_cvt_pk_bf16_f32 v57, v30, v31
    v_add_u32 v5, s52, v9
    v_mfma_f32_16x16x32_bf16 v[100:103], a[204:207], v[44:47], v[100:103]
    v_exp_f32 v32, v32
    v_mfma_f32_16x16x32_bf16 v[100:103], a[228:231], v[48:51], v[100:103]
    v_exp_f32 v33, v33
    v_mfma_f32_16x16x32_bf16 v[104:107], a[208:211], v[44:47], v[104:107]
    ds_read_b128 a[80:83], v3 offset:2048
    v_cvt_pk_bf16_f32 v58, v32, v33
    v_mfma_f32_16x16x32_bf16 v[104:107], a[232:235], v[48:51], v[104:107]
    v_exp_f32 v34, v34
    v_mfma_f32_16x16x32_bf16 v[108:111], a[212:215], v[44:47], v[108:111]
    s_sub_u32 s55, s55, 1
    v_exp_f32 v35, v35
    v_mfma_f32_16x16x32_bf16 v[108:111], a[236:239], v[48:51], v[108:111]
    ds_read_b128 a[84:87], v3 offset:3072
    v_cvt_pk_bf16_f32 v59, v34, v35
    v_smfmac_f32_16x16x64_bf16 v[112:115], a[244:247], v[44:51], v255
    s_cbranch_vccnz L_sk12_0
    global_load_lds_dwordx4 v10, s[38:39] offset:0 sc1
    global_load_lds_dwordx4 v10, s[38:39] offset:1024 sc1
    global_load_lds_dwordx4 v10, s[38:39] offset:2048 sc1
    global_load_lds_dwordx4 v10, s[38:39] offset:3072 sc1
L_sk12_0:
    s_cbranch_scc0 L_back12
    v_mfma_f32_16x16x32_bf16 v[28:31], a[120:123], a[24:27], v[80:83]
    s_mul_i32 s51, s48, 7168
    v_exp_f32 v20, v20
    v_mfma_f32_16x16x32_bf16 v[28:31], a[124:127], a[28:31], v[28:31]
    s_add_u32 s51, s51, 98304
    v_exp_f32 v21, v21
    v_mfma_f32_16x16x32_bf16 v[28:31], a[128:131], a[32:35], v[28:31]
    v_add_u32 v200, s51, v1
    v_cvt_pk_bf16_f32 v60, v20, v21
    v_mfma_f32_16x16x32_bf16 v[32:35], a[132:135], a[24:27], v[80:83]
    s_mov_b32 s50, 310378496
    v_exp_f32 v22, v22
    v_mfma_f32_16x16x32_bf16 v[32:35], a[136:139], a[28:31], v[32:35]
    s_mov_b32 s18, 1258291200
    v_exp_f32 v23, v23
    v_mfma_f32_16x16x32_bf16 v[32:35], a[140:143], a[32:35], v[32:35]
    s_nop 0
    v_cvt_pk_bf16_f32 v61, v22, v23
    v_add_f32 v112, v112, v113
    v_mfma_f32_16x16x32_bf16 v[116:119], a[192:195], v[52:55], v[116:119]
    v_exp_f32 v24, v24
    v_rcp_f32 v36, v112
    v_mfma_f32_16x16x32_bf16 v[116:119], a[216:219], v[56:59], v[116:119]
    v_exp_f32 v25, v25
    v_mul_f32 v88, v88, v36
    v_mul_f32 v89, v89, v36
    v_mfma_f32_16x16x32_bf16 v[120:123], a[196:199], v[52:55], v[120:123]
    s_nop 0
    v_cvt_pk_bf16_f32 v62, v24, v25
    v_mul_f32 v90, v90, v36
    v_mul_f32 v91, v91, v36
    v_mfma_f32_16x16x32_bf16 v[120:123], a[220:223], v[56:59], v[120:123]
    v_exp_f32 v26, v26
    v_mul_f32 v92, v92, v36
    v_mul_f32 v93, v93, v36
    v_mfma_f32_16x16x32_bf16 v[124:127], a[200:203], v[52:55], v[124:127]
    v_exp_f32 v27, v27
    v_mul_f32 v94, v94, v36
    v_mul_f32 v95, v95, v36
    v_mfma_f32_16x16x32_bf16 v[124:127], a[224:227], v[56:59], v[124:127]
    s_nop 0
    v_cvt_pk_bf16_f32 v63, v26, v27
    v_cvt_pk_bf16_f32 v88, v88, v89
    v_cvt_pk_bf16_f32 v89, v90, v91
    v_smfmac_f32_16x16x64_bf16 v[140:143], a[244:247], v[52:59], v255
    v_exp_f32 v28, v28
    v_cvt_pk_bf16_f32 v90, v92, v93
    v_cvt_pk_bf16_f32 v91, v94, v95
    buffer_store_dwordx4 v[88:91], v13, s[28:31], 0 offen offset:0 sc0 sc1
    v_mfma_f32_16x16x32_bf16 v[128:131], a[204:207], v[52:55], v[128:131]
    v_exp_f32 v29, v29
    v_mul_f32 v96, v96, v36
    v_mul_f32 v97, v97, v36
    v_mfma_f32_16x16x32_bf16 v[128:131], a[228:231], v[56:59], v[128:131]
    s_nop 0
    v_cvt_pk_bf16_f32 v64, v28, v29
    v_mul_f32 v98, v98, v36
    v_mul_f32 v99, v99, v36
    v_mfma_f32_16x16x32_bf16 v[132:135], a[208:211], v[52:55], v[132:135]
    v_exp_f32 v30, v30
    v_mul_f32 v100, v100, v36
    v_mul_f32 v101, v101, v36
    v_mfma_f32_16x16x32_bf16 v[132:135], a[232:235], v[56:59], v[132:135]
    v_exp_f32 v31, v31
    v_mul_f32 v102, v102, v36
    v_mul_f32 v103, v103, v36
    v_mfma_f32_16x16x32_bf16 v[136:139], a[212:215], v[52:55], v[136:139]
    s_nop 0
    v_cvt_pk_bf16_f32 v65, v30, v31
    v_cvt_pk_bf16_f32 v96, v96, v97
    v_cvt_pk_bf16_f32 v97, v98, v99
    v_mfma_f32_16x16x32_bf16 v[136:139], a[236:239], v[56:59], v[136:139]
    v_exp_f32 v32, v32
    v_cvt_pk_bf16_f32 v98, v100, v101
    v_cvt_pk_bf16_f32 v99, v102, v103
    buffer_store_dwordx4 v[96:99], v13, s[28:31], 0 offen offset:64 sc0 sc1
    v_exp_f32 v33, v33
    s_nop 0
    v_cvt_pk_bf16_f32 v66, v32, v33
    v_exp_f32 v34, v34
    v_exp_f32 v35, v35
    v_add_f32 v140, v140, v141
    v_cvt_pk_bf16_f32 v67, v34, v35
    v_rcp_f32 v38, v140
    s_nop 0
    v_smfmac_f32_16x16x64_bf16 v[168:171], a[244:247], v[60:67], v255
    v_mfma_f32_16x16x32_bf16 v[144:147], a[192:195], v[60:63], v[144:147]
    v_mul_f32 v104, v104, v36
    v_mul_f32 v105, v105, v36
    v_mfma_f32_16x16x32_bf16 v[144:147], a[216:219], v[64:67], v[144:147]
    v_mul_f32 v106, v106, v36
    v_mul_f32 v107, v107, v36
    v_mfma_f32_16x16x32_bf16 v[148:151], a[196:199], v[60:63], v[148:151]
    v_mul_f32 v108, v108, v36
    v_mul_f32 v109, v109, v36
    v_mfma_f32_16x16x32_bf16 v[148:151], a[220:223], v[64:67], v[148:151]
    v_mul_f32 v110, v110, v36
    v_mul_f32 v111, v111, v36
    v_mfma_f32_16x16x32_bf16 v[152:155], a[200:203], v[60:63], v[152:155]
    v_cvt_pk_bf16_f32 v104, v104, v105
    v_cvt_pk_bf16_f32 v105, v106, v107
    v_mfma_f32_16x16x32_bf16 v[152:155], a[224:227], v[64:67], v[152:155]
    v_cvt_pk_bf16_f32 v106, v108, v109
    v_cvt_pk_bf16_f32 v107, v110, v111
    v_mfma_f32_16x16x32_bf16 v[156:159], a[204:207], v[60:63], v[156:159]
    buffer_store_dwordx4 v[104:107], v13, s[28:31], 0 offen offset:128 sc0 sc1
    v_mul_f32 v116, v116, v38
    v_mfma_f32_16x16x32_bf16 v[156:159], a[228:231], v[64:67], v[156:159]
    v_mul_f32 v117, v117, v38
    v_mul_f32 v118, v118, v38
    v_mfma_f32_16x16x32_bf16 v[160:163], a[208:211], v[60:63], v[160:163]
    v_mul_f32 v119, v119, v38
    v_mul_f32 v120, v120, v38
    v_mfma_f32_16x16x32_bf16 v[160:163], a[232:235], v[64:67], v[160:163]
    v_mul_f32 v121, v121, v38
    v_mul_f32 v122, v122, v38
    v_mfma_f32_16x16x32_bf16 v[164:167], a[212:215], v[60:63], v[164:167]
    v_mul_f32 v123, v123, v38
    v_cvt_pk_bf16_f32 v116, v116, v117
    v_mfma_f32_16x16x32_bf16 v[164:167], a[236:239], v[64:67], v[164:167]
    v_cvt_pk_bf16_f32 v117, v118, v119
    v_cvt_pk_bf16_f32 v118, v120, v121
    v_cvt_pk_bf16_f32 v119, v122, v123
    buffer_store_dwordx4 v[116:119], v14, s[28:31], 0 offen offset:0 sc0 sc1
    v_add_f32 v168, v168, v169
    v_subrev_u32 v37, s50, v112
    v_cmp_le_u32 s[64:65], s18, v37
    v_subrev_u32 v39, s50, v140
    v_cmp_le_u32 s[66:67], s18, v39
    v_subrev_u32 v41, s50, v168
    v_cmp_le_u32 vcc, s18, v41
    v_rcp_f32 v40, v168
    s_or_b64 s[64:65], s[64:65], s[66:67]
    s_or_b64 s[64:65], s[64:65], vcc
    s_cselect_b32 s51, 1, 0
    v_mov_b32 v197, s51
    ds_write_b64 v200, v[196:197] offset:6144
    v_add_u32 v18, 98304, v1
    v_pk_mul_f32 v[124:125], v[124:125], v[38:39] op_sel_hi:[1,0]
    v_pk_mul_f32 v[126:127], v[126:127], v[38:39] op_sel_hi:[1,0]
    v_pk_mul_f32 v[128:129], v[128:129], v[38:39] op_sel_hi:[1,0]
    v_pk_mul_f32 v[130:131], v[130:131], v[38:39] op_sel_hi:[1,0]
    v_cvt_pk_bf16_f32 v124, v124, v125
    v_cvt_pk_bf16_f32 v125, v126, v127
    v_cvt_pk_bf16_f32 v126, v128, v129
    v_cvt_pk_bf16_f32 v127, v130, v131
    buffer_store_dwordx4 v[124:127], v14, s[28:31], 0 offen offset:64 sc0 sc1
    v_pk_mul_f32 v[132:133], v[132:133], v[38:39] op_sel_hi:[1,0]
    v_pk_mul_f32 v[134:135], v[134:135], v[38:39] op_sel_hi:[1,0]
    v_pk_mul_f32 v[136:137], v[136:137], v[38:39] op_sel_hi:[1,0]
    v_pk_mul_f32 v[138:139], v[138:139], v[38:39] op_sel_hi:[1,0]
    v_cvt_pk_bf16_f32 v132, v132, v133
    v_cvt_pk_bf16_f32 v133, v134, v135
    v_cvt_pk_bf16_f32 v134, v136, v137
    v_cvt_pk_bf16_f32 v135, v138, v139
    buffer_store_dwordx4 v[132:135], v14, s[28:31], 0 offen offset:128 sc0 sc1
    v_pk_mul_f32 v[144:145], v[144:145], v[40:41] op_sel_hi:[1,0]
    v_pk_mul_f32 v[146:147], v[146:147], v[40:41] op_sel_hi:[1,0]
    v_pk_mul_f32 v[148:149], v[148:149], v[40:41] op_sel_hi:[1,0]
    v_pk_mul_f32 v[150:151], v[150:151], v[40:41] op_sel_hi:[1,0]
    v_cvt_pk_bf16_f32 v144, v144, v145
    v_cvt_pk_bf16_f32 v145, v146, v147
    v_cvt_pk_bf16_f32 v146, v148, v149
    v_cvt_pk_bf16_f32 v147, v150, v151
    buffer_store_dwordx4 v[144:147], v15, s[28:31], 0 offen offset:0 sc0 sc1
    v_pk_mul_f32 v[152:153], v[152:153], v[40:41] op_sel_hi:[1,0]
    v_pk_mul_f32 v[154:155], v[154:155], v[40:41] op_sel_hi:[1,0]
    v_pk_mul_f32 v[156:157], v[156:157], v[40:41] op_sel_hi:[1,0]
    v_pk_mul_f32 v[158:159], v[158:159], v[40:41] op_sel_hi:[1,0]
    v_cvt_pk_bf16_f32 v152, v152, v153
    v_cvt_pk_bf16_f32 v153, v154, v155
    v_cvt_pk_bf16_f32 v154, v156, v157
    v_cvt_pk_bf16_f32 v155, v158, v159
    buffer_store_dwordx4 v[152:155], v15, s[28:31], 0 offen offset:64 sc0 sc1
    v_pk_mul_f32 v[160:161], v[160:161], v[40:41] op_sel_hi:[1,0]
    v_pk_mul_f32 v[162:163], v[162:163], v[40:41] op_sel_hi:[1,0]
    v_pk_mul_f32 v[164:165], v[164:165], v[40:41] op_sel_hi:[1,0]
    v_pk_mul_f32 v[166:167], v[166:167], v[40:41] op_sel_hi:[1,0]
    v_cvt_pk_bf16_f32 v160, v160, v161
    v_cvt_pk_bf16_f32 v161, v162, v163
    v_cvt_pk_bf16_f32 v162, v164, v165
    v_cvt_pk_bf16_f32 v163, v166, v167
    buffer_store_dwordx4 v[160:163], v15, s[28:31], 0 offen offset:128 sc0 sc1
    s_waitcnt lgkmcnt(0)
    s_barrier
    ds_read_b64 v[20:21], v18 offset:6144
    ds_read_b64 v[22:23], v18 offset:13312
    ds_read_b64 v[24:25], v18 offset:20480
    ds_read_b64 v[26:27], v18 offset:27648
    s_waitcnt lgkmcnt(0)
    v_or_b32 v21, v21, v23
    v_or3_b32 v21, v21, v25, v27
    v_cmp_ne_u32 s[64:65], 0, v21
    s_mov_b64 s[66:67], 0
    s_branch L_notstore
L_touch12:
    s_setpc_b64 s[66:67]
L_notstore:
    s_or_b64 s[64:65], s[64:65], s[66:67]
    s_cselect_b32 s50, 1, 0
    s_andn2_b32 s50, s50, s68
    s_cbranch_scc0 L_end
    s_mov_b32 s68, 1
    s_waitcnt vmcnt(0)
    s_barrier
    v_mov_b32 v72, 0xff800000
    v_mov_b32 v76, 0xff800000
    v_mov_b32 v80, 0xff800000
    v_mov_b32 v84, 0xff800000
    s_mov_b32 s50, 0
L_maxloop:
    s_add_u32 s51, s50, 4096
    buffer_load_dwordx4 a[48:51], v1, s[20:23], s50 offen offset:0 sc1
    buffer_load_dwordx4 a[52:55], v1, s[20:23], s50 offen offset:1024 sc1
    buffer_load_dwordx4 a[56:59], v1, s[20:23], s50 offen offset:2048 sc1
    buffer_load_dwordx4 a[60:63], v1, s[20:23], s50 offen offset:3072 sc1
    buffer_load_dwordx4 a[64:67], v1, s[20:23], s51 offen offset:0 sc1
    buffer_load_dwordx4 a[68:71], v1, s[20:23], s51 offen offset:1024 sc1
    s_waitcnt vmcnt(0)
    v_mfma_f32_16x16x32_bf16 v[20:23], a[48:51], a[0:3], 0
    v_mfma_f32_16x16x32_bf16 v[20:23], a[52:55], a[4:7], v[20:23]
    v_mfma_f32_16x16x32_bf16 v[20:23], a[56:59], a[8:11], v[20:23]
    v_mfma_f32_16x16x32_bf16 v[24:27], a[60:63], a[0:3], 0
    v_mfma_f32_16x16x32_bf16 v[24:27], a[64:67], a[4:7], v[24:27]
    v_mfma_f32_16x16x32_bf16 v[24:27], a[68:71], a[8:11], v[24:27]
    s_nop 7
    s_nop 1
    v_max3_f32 v72, v72, v20, v21
    v_max3_f32 v72, v72, v22, v23
    v_max3_f32 v72, v72, v24, v25
    v_max3_f32 v72, v72, v26, v27
    v_mfma_f32_16x16x32_bf16 v[20:23], a[48:51], a[12:15], 0
    v_mfma_f32_16x16x32_bf16 v[20:23], a[52:55], a[16:19], v[20:23]
    v_mfma_f32_16x16x32_bf16 v[20:23], a[56:59], a[20:23], v[20:23]
    v_mfma_f32_16x16x32_bf16 v[24:27], a[60:63], a[12:15], 0
    v_mfma_f32_16x16x32_bf16 v[24:27], a[64:67], a[16:19], v[24:27]
    v_mfma_f32_16x16x32_bf16 v[24:27], a[68:71], a[20:23], v[24:27]
    s_nop 7
    s_nop 1
    v_max3_f32 v76, v76, v20, v21
    v_max3_f32 v76, v76, v22, v23
    v_max3_f32 v76, v76, v24, v25
    v_max3_f32 v76, v76, v26, v27
    v_mfma_f32_16x16x32_bf16 v[20:23], a[48:51], a[24:27], 0
    v_mfma_f32_16x16x32_bf16 v[20:23], a[52:55], a[28:31], v[20:23]
    v_mfma_f32_16x16x32_bf16 v[20:23], a[56:59], a[32:35], v[20:23]
    v_mfma_f32_16x16x32_bf16 v[24:27], a[60:63], a[24:27], 0
    v_mfma_f32_16x16x32_bf16 v[24:27], a[64:67], a[28:31], v[24:27]
    v_mfma_f32_16x16x32_bf16 v[24:27], a[68:71], a[32:35], v[24:27]
    s_nop 7
    s_nop 1
    v_max3_f32 v80, v80, v20, v21
    v_max3_f32 v80, v80, v22, v23
    v_max3_f32 v80, v80, v24, v25
    v_max3_f32 v80, v80, v26, v27
    v_mfma_f32_16x16x32_bf16 v[20:23], a[48:51], a[36:39], 0
    v_mfma_f32_16x16x32_bf16 v[20:23], a[52:55], a[40:43], v[20:23]
    v_mfma_f32_16x16x32_bf16 v[20:23], a[56:59], a[44:47], v[20:23]
    v_mfma_f32_16x16x32_bf16 v[24:27], a[60:63], a[36:39], 0
    v_mfma_f32_16x16x32_bf16 v[24:27], a[64:67], a[40:43], v[24:27]
    v_mfma_f32_16x16x32_bf16 v[24:27], a[68:71], a[44:47], v[24:27]
    s_nop 7
    s_nop 1
    v_max3_f32 v84, v84, v20, v21
    v_max3_f32 v84, v84, v22, v23
    v_max3_f32 v84, v84, v24, v25
    v_max3_f32 v84, v84, v26, v27
    s_add_u32 s50, s50, 12288
    s_cmp_lt_u32 s50, 393216
    s_cbranch_scc1 L_maxloop
    v_mov_b32 v73, v72
    v_mov_b32 v77, v76
    v_mov_b32 v81, v80
    v_mov_b32 v85, v84
    v_permlane32_swap_b32 v72, v73
    v_permlane32_swap_b32 v76, v77
    v_permlane32_swap_b32 v80, v81
    v_permlane32_swap_b32 v84, v85
    v_max_f32 v72, v72, v73
    v_max_f32 v76, v76, v77
    v_max_f32 v80, v80, v81
    v_max_f32 v84, v84, v85
    v_mov_b32 v73, v72
    v_mov_b32 v77, v76
    v_mov_b32 v81, v80
    v_mov_b32 v85, v84
    v_permlane16_swap_b32 v72, v73
    v_permlane16_swap_b32 v76, v77
    v_permlane16_swap_b32 v80, v81
    v_permlane16_swap_b32 v84, v85
    v_max_f32 v72, v72, v73
    v_max_f32 v76, v76, v77
    v_max_f32 v80, v80, v81
    v_max_f32 v84, v84, v85
    v_sub_f32 v72, 0, v72
    v_sub_f32 v76, 0, v76
    v_sub_f32 v80, 0, v80
    v_sub_f32 v84, 0, v84
    v_mov_b32 v73, v72
    v_mov_b32 v74, v72
    v_mov_b32 v75, v72
    v_mov_b32 v77, v76
    v_mov_b32 v78, v76
    v_mov_b32 v79, v76
    v_mov_b32 v81, v80
    v_mov_b32 v82, v80
    v_mov_b32 v83, v80
    v_mov_b32 v85, v84
    v_mov_b32 v86, v84
    v_mov_b32 v87, v84
    v_mfma_f32_32x32x16_bf16 v[88:103], a[248:251], a[248:251], 0
    v_mfma_f32_32x32x16_bf16 v[104:119], a[248:251], a[248:251], 0
    v_mfma_f32_32x32x16_bf16 v[120:135], a[248:251], a[248:251], 0
    v_mfma_f32_32x32x16_bf16 v[136:151], a[248:251], a[248:251], 0
    v_mfma_f32_32x32x16_bf16 v[152:167], a[248:251], a[248:251], 0
    v_mfma_f32_32x32x16_bf16 v[168:183], a[248:251], a[248:251], 0
    v_mfma_f32_32x32x16_bf16 v[184:199], a[248:251], a[248:251], 0
    v_mfma_f32_32x32x16_bf16 a[192:207], a[248:251], a[248:251], 0
    v_mfma_f32_32x32x16_bf16 a[208:223], a[248:251], a[248:251], 0
    v_mfma_f32_32x32x16_bf16 a[224:239], a[248:251], a[248:251], 0
    s_mov_b32 s52, 49152
    s_mov_b32 s53, 98304
    s_mov_b32 s54, 0
    s_mov_b32 s55, 7
    v_mov_b32 v60, 0
    v_mov_b32 v61, 0
    v_mov_b32 v62, 0
    v_mov_b32 v63, 0
    v_mov_b32 v64, 0
    v_mov_b32 v65, 0
    v_mov_b32 v66, 0
    v_mov_b32 v67, 0
    v_mov_b32 v2, v6
    v_mov_b32 v3, v7
    v_mov_b32 v4, v8
    v_mov_b32 v5, v9
    s_mov_b32 s62, 0x01010101
    s_mov_b32 s63, 0x01010101
    s_andn2_b64 s[64:65], s[62:63], s[60:61]
    s_branch L_restart
L_slow13:
    s_mov_b32 s71, 0
L_spin2_13:
    s_sleep 8
    buffer_load_dword v18, v17, s[20:23], 0 offen sc1
L_spin2_13_w:
    s_waitcnt vmcnt(0)
    v_cmp_ne_u32 s[64:65], s69, v18
    s_nop 0
    s_wqm_b64 s[64:65], s[64:65]
    s_lshr_b64 s[66:67], s[64:65], 4
    s_or_b64 s[64:65], s[64:65], s[66:67]
    s_and_b64 s[60:61], s[60:61], s[64:65]
    s_andn2_b64 s[64:65], s[62:63], s[60:61]
    s_cbranch_scc1 L_spin2_13_ok
    s_add_u32 s71, s71, 1
    s_cmp_lt_u32 s71, 0x4000
    s_cbranch_scc1 L_spin2_13
    s_mov_b64 s[60:61], 0
    s_andn2_b64 s[64:65], s[62:63], s[60:61]
L_spin2_13_ok:
    s_branch L_pick13
L_lw13:
    ds_read_b32 v242, v243
    s_waitcnt lgkmcnt(0)
    v_cmp_lt_u32 s[66:67], s55, v242
    s_cmp_lg_u64 s[66:67], 0
    s_cbranch_scc1 L_lw13
    s_branch L_lwr13
L_slow12:
    s_mov_b32 s71, 0
L_spin2_12:
    s_sleep 8
    buffer_load_dword v18, v17, s[20:23], 0 offen sc1
L_spin2_12_w:
    s_waitcnt vmcnt(0)
    v_cmp_ne_u32 s[64:65], s69, v18
    s_nop 0
    s_wqm_b64 s[64:65], s[64:65]
    s_lshr_b64 s[66:67], s[64:65], 4
    s_or_b64 s[64:65], s[64:65], s[66:67]
    s_and_b64 s[60:61], s[60:61], s[64:65]
    s_andn2_b64 s[64:65], s[62:63], s[60:61]
    s_cbranch_scc1 L_spin2_12_ok
    s_add_u32 s71, s71, 1
    s_cmp_lt_u32 s71, 0x4000
    s_cbranch_scc1 L_spin2_12
    s_mov_b64 s[60:61], 0
    s_andn2_b64 s[64:65], s[62:63], s[60:61]
L_spin2_12_ok:
    s_branch L_pick12
L_lw12:
    ds_read_b32 v242, v243
    s_waitcnt lgkmcnt(0)
    v_cmp_lt_u32 s[66:67], s55, v242
    s_cmp_lg_u64 s[66:67], 0
    s_cbranch_scc1 L_lw12
    s_branch L_lwr12
L_end:
    s_endpgm
.section .rodata,"a"
.p2align 6
.amdhsa_kernel standalone__window_attn_twins__vision_kernel
  .amdhsa_next_free_vgpr 508
  .amdhsa_next_free_sgpr 100
  .amdhsa_accum_offset 256
  .amdhsa_group_segment_fixed_size 0
  .amdhsa_kernarg_size 56
  .amdhsa_user_sgpr_count 2
  .amdhsa_user_sgpr_kernarg_segment_ptr 1
  .amdhsa_system_sgpr_workgroup_id_x 1
.end_amdhsa_kernel
```
